```python
import torch

def _softmax(x, axis=-1):
    return torch.softmax(x, dim=axis)
def _gelu(x):
    return torch.nn.functional.gelu(x, approximate="tanh")
def _silu(x):
    return torch.nn.functional.silu(x)
def _sigmoid(x):
    return torch.sigmoid(x)
def _layernorm(x, axis=-1, eps=1e-5):
    m = x.mean(dim=axis, keepdim=True)
    v = x.var(dim=axis, keepdim=True, unbiased=False)
    return (x - m) / torch.sqrt(v + eps)
def _scatter_add(tgt, idx, src, axis=0):
    return tgt.clone().index_add_(axis, idx, src)
def _segment_sum(src, seg, n):
    out = torch.zeros((n,) + src.shape[1:], dtype=src.dtype)
    return out.index_add_(0, seg, src)
def _pad(x, pw):
    flat = tuple(v for pair in reversed(pw) for v in pair)
    return torch.nn.functional.pad(x, flat)

kernel_name = 'recurrent_scan__ssm_conv_s4__dense_activation_mish__prompt'

def setup_inputs():

    _w = (lambda a: (lambda t: t.to(torch.bfloat16) if t.is_floating_point() else t)(torch.as_tensor(a)))
    def _A_setup():
        B, L, D, N = 1, 2048, 640, 192
        A_re = -(lambda _x: torch.exp(torch.as_tensor(_x)))((lambda *s: torch.randn(*s, dtype=torch.bfloat16) * 3.2)(D, N))
        A_im = torch.pi * (lambda *s: torch.randn(*s, dtype=torch.bfloat16) * 0.2)(D, N)
        B_re = (lambda *s: torch.randn(*s, dtype=torch.bfloat16) * 0.2)(D, N)
        B_im = (lambda *s: torch.randn(*s, dtype=torch.bfloat16) * 0.2)(D, N)
        C_re = (lambda *s: torch.randn(*s, dtype=torch.bfloat16) * 0.2)(D, N)
        C_im = (lambda *s: torch.randn(*s, dtype=torch.bfloat16) * 0.2)(D, N)
        log_dt = (lambda *s: torch.randn(*s, dtype=torch.bfloat16) * 0.2)(D) * 0.5 - 4.0
        Dskip = (lambda *s: torch.randn(*s, dtype=torch.bfloat16) * 0.2)(D)
        return {
            "u": _w((lambda *s: torch.randn(*s, dtype=torch.bfloat16) * 0.05)(B, L, D)),
            "A_re": _w(A_re),
            "A_im": _w(A_im),
            "B_re": _w(B_re),
            "B_im": _w(B_im),
            "C_re": _w(C_re),
            "C_im": _w(C_im),
            "log_dt": _w(log_dt),
            "Dskip": _w(Dskip),
        }
    _A_in = _A_setup()

    def _B_setup():
        B, S, D, F = 1, 2048, 640, 1536
        return {
            "x": _w((lambda *s: torch.randn(*s, dtype=torch.bfloat16) * 0.05)(B, S, D)),
            "w1": _w((lambda *s: torch.randn(*s, dtype=torch.bfloat16) * 0.8)(D, F) * (D ** -0.5)),
            "b1": _w((lambda *s: torch.randn(*s, dtype=torch.bfloat16) * 0.1)(F)),
            "w2": _w((lambda *s: torch.randn(*s, dtype=torch.bfloat16) * 0.1)(F, D) * (F ** -0.5)),
        }
    _B_in = _B_setup()

    return {
        "A_u": _A_in["u"],
        "A_A_re": _A_in["A_re"],
        "A_A_im": _A_in["A_im"],
        "A_B_re": _A_in["B_re"],
        "A_B_im": _A_in["B_im"],
        "A_C_re": _A_in["C_re"],
        "A_C_im": _A_in["C_im"],
        "A_log_dt": _A_in["log_dt"],
        "A_Dskip": _A_in["Dskip"],
        "B_x": _B_in["x"],
        "B_w1": _B_in["w1"],
        "B_b1": _B_in["b1"],
        "B_w2": _B_in["w2"],
    }

def reference(A_u, A_A_re, A_A_im, A_B_re, A_B_im, A_C_re, A_C_im, A_log_dt, A_Dskip, B_x, B_w1, B_b1, B_w2):
    def _A_ref(u, A_re, A_im, B_re, B_im, C_re, C_im, log_dt, Dskip):
        Bsz, L, D = u.shape
        dt = torch.exp(log_dt)[:, None]
        A = A_re + 1j * A_im
        Bc = B_re + 1j * B_im
        Cc = C_re + 1j * C_im
        logdA = dt * A
        dB = dt * Bc
        l = (lambda x, dt: x.to(dt))(torch.arange(L), A_re.dtype)
        P = torch.exp(logdA[:, :, None] * l[None, None, :])
        K = torch.einsum("dn,dnl,dn->dl", Cc, P, dB).real
        L2 = 2 * L
        Kp = _pad(K, ((0, 0), (0, L)))
        up = (lambda x, *d: x.permute(*d))(u, 0, 2, 1)
        up = _pad(up, ((0, 0), (0, 0), (0, L)))
        Kf = (lambda x, axes=(-2,-1): torch.fft.rfft2(x.float(), dim=axes))(Kp[:, None, :], axes=(-2, -1))
        Uf = (lambda x, axes=(-2,-1): torch.fft.rfft2(x.float(), dim=axes))(up[:, :, None, :], axes=(-2, -1))
        Yf = Uf * Kf[None, :, :, :]
        y = (lambda x, s, axes=(-2,-1): torch.fft.irfft2(x, s=s, dim=axes).to(torch.bfloat16))(Yf, (1, L2), axes=(-2, -1))[:, :, 0, :L]
        y = (lambda x, *d: x.permute(*d))(y, 0, 2, 1) + u * Dskip[None, None, :]
        return y

    def _B_ref(x, w1, b1, w2):
        h = torch.einsum("bsd,df->bsf", x, w1) + b1
        sp = torch.log1p(torch.exp(-torch.abs(h))) + torch.where(h > 0, h, torch.zeros_like(h))
        act = h * torch.tanh(sp)
        return torch.einsum("bsf,fd->bsd", act, w2)

    x = A_u
    xn = _layernorm(x, axis=-1)
    s = _A_ref(xn, A_A_re, A_A_im, A_B_re, A_B_im, A_C_re, A_C_im, A_log_dt, A_Dskip)
    g = _silu(_B_ref(xn, B_w1, B_b1, B_w2))
    return x + s * g
```

```asm
; @launch grid=(256,1,1) block=(512,1,1) lds=163840
.amdgcn_target "amdgcn-amd-amdhsa--gfx950"
.text
.globl recurrent_scan__ssm_conv_s4__dense_activation_mish__prompt_kernel
.p2align 8
.type recurrent_scan__ssm_conv_s4__dense_activation_mish__prompt_kernel,@function
recurrent_scan__ssm_conv_s4__dense_activation_mish__prompt_kernel:
    s_cmp_ge_u32 s2, 256
    s_cbranch_scc1 L_end
    v_lshrrev_b32 v1, 6, v0
    v_and_b32 v0, 63, v0
    v_lshlrev_b32 v2, 2, v0
    v_add_u32 v2, 159744, v2
    v_readfirstlane_b32 s3, v1
    v_mov_b32 v1, 0
    ds_write_b32 v2, v1
    s_waitcnt lgkmcnt(0)
    s_load_dwordx16 s[8:23], s[0:1], 0
    s_load_dwordx16 s[24:39], s[0:1], 64
    s_barrier
    s_cmp_lt_u32 s3, 4
    s_cbranch_scc1 L_compute
    s_cmp_eq_u32 s3, 4
    s_cbranch_scc1 L_loader
    s_setprio 3
    s_sub_u32 s41, s3, 5
    s_mul_i32 s40, s41, 20480
    s_add_u32 s40, s40, 98304
    s_lshl_b32 s42, s2, 1
    s_add_u32 s42, s42, s41
    s_cmp_lt_u32 s3, 7
    s_cbranch_scc1 L_kc
    s_add_u32 s42, s2, 512
    s_cmp_lt_u32 s2, 128
    s_cbranch_scc1 L_kc
    s_bfe_u32 s42, s2, 0x20001
    s_lshl_b32 s42, s42, 5
    s_bfe_u32 s41, s2, 0x40003
    s_lshl_b32 s41, s41, 1
    s_add_u32 s42, s42, s41
    s_and_b32 s41, s2, 1
    s_add_u32 s42, s42, s41
    s_setprio 3
    v_lshrrev_b32 v1, 4, v0
    v_and_b32 v2, 15, v0
    v_mul_u32_u24 v12, 1280, v1
    v_lshl_add_u32 v12, v2, 4, v12
    s_mul_i32 s44, s42, 20480
    v_add_u32 v12, s44, v12
    v_add_u32 v13, 5120, v12
    v_add_u32 v14, 10240, v12
    v_add_u32 v15, 15360, v12
    v_mov_b32 v6, 0
    s_waitcnt lgkmcnt(0)
    s_cmp_lg_u32 s42, 0
    s_cbranch_scc1 L_notag_1
    s_memrealtime s[48:49]
    s_waitcnt lgkmcnt(0)
    s_or_b32 s48, s48, 1
    v_mov_b32 v8, s48
    v_mov_b32 v9, s49
    global_store_dwordx2 v6, v[8:9], s[36:37] sc1
L_notag_1:
    v_mov_b32 v64, 159744
    s_mov_b32 s45, 0
L_sgate_2:
    s_sleep 4
    ds_read_b32 v65, v64
    s_add_u32 s45, s45, 1
    s_cmp_gt_u32 s45, 0x10000
    s_waitcnt lgkmcnt(0)
    s_cbranch_scc1 L_sgateok_3
    v_cmp_eq_u32 vcc, 0, v65
    s_cbranch_vccnz L_sgate_2
L_sgateok_3:
    global_load_dwordx4 v[80:83], v12, s[8:9] offset:0
    global_load_dwordx4 v[84:87], v12, s[8:9] offset:256
    global_load_dwordx4 v[88:91], v12, s[8:9] offset:512
    global_load_dwordx4 v[92:95], v12, s[8:9] offset:768
    global_load_dwordx4 v[96:99], v12, s[8:9] offset:1024
    global_load_dwordx4 v[100:103], v13, s[8:9] offset:0
    global_load_dwordx4 v[104:107], v13, s[8:9] offset:256
    global_load_dwordx4 v[108:111], v13, s[8:9] offset:512
    global_load_dwordx4 v[112:115], v13, s[8:9] offset:768
    global_load_dwordx4 v[116:119], v13, s[8:9] offset:1024
    global_load_dwordx4 v[120:123], v14, s[8:9] offset:0
    global_load_dwordx4 v[124:127], v14, s[8:9] offset:256
    global_load_dwordx4 v[128:131], v14, s[8:9] offset:512
    global_load_dwordx4 v[132:135], v14, s[8:9] offset:768
    global_load_dwordx4 v[136:139], v14, s[8:9] offset:1024
    global_load_dwordx4 v[140:143], v15, s[8:9] offset:0
    global_load_dwordx4 v[144:147], v15, s[8:9] offset:256
    global_load_dwordx4 v[148:151], v15, s[8:9] offset:512
    global_load_dwordx4 v[152:155], v15, s[8:9] offset:768
    global_load_dwordx4 v[156:159], v15, s[8:9] offset:1024
    s_add_u32 s52, s38, 0x7e8000
    s_addc_u32 s53, s39, 0
    s_and_b32 s53, s53, 0xffff
    s_mov_b32 s54, 0x4000
    s_mov_b32 s55, 0x00020000
    s_add_u32 s56, s38, 0x7ec000
    s_addc_u32 s57, s39, 0
    s_and_b32 s57, s57, 0xffff
    s_mov_b32 s58, 0xb000
    s_mov_b32 s59, 0x00020000
    s_add_u32 s60, s38, 0x7e0000
    s_addc_u32 s61, s39, 0
    s_and_b32 s61, s61, 0xffff
    s_mov_b32 s62, 0x8000
    s_mov_b32 s63, 0x00020000
    s_mov_b32 s45, 0x3f803f80
    v_lshlrev_b32 v7, 4, v0
    v_lshl_add_u32 v22, v2, 2, v1
    s_lshl_b32 s48, s42, 4
    v_add_u32 v22, s48, v22
    v_lshlrev_b32 v23, 2, v22
    v_lshlrev_b32 v22, 4, v22
    v_mov_b32 v24, 0
    v_mov_b32 v25, 0
    v_mov_b32 v26, 0
    v_mov_b32 v27, 0
    v_mov_b32 v28, 0
    v_mov_b32 v29, 0
    v_mov_b32 v30, 0
    v_mov_b32 v31, 0
    s_waitcnt vmcnt(15)
    v_dot2_f32_bf16 v24, v80, s45, v24
    v_dot2_f32_bf16 v25, v80, v80, v25
    v_dot2_f32_bf16 v24, v81, s45, v24
    v_dot2_f32_bf16 v25, v81, v81, v25
    v_dot2_f32_bf16 v24, v82, s45, v24
    v_dot2_f32_bf16 v25, v82, v82, v25
    v_dot2_f32_bf16 v24, v83, s45, v24
    v_dot2_f32_bf16 v25, v83, v83, v25
    v_dot2_f32_bf16 v24, v84, s45, v24
    v_dot2_f32_bf16 v25, v84, v84, v25
    v_dot2_f32_bf16 v24, v85, s45, v24
    v_dot2_f32_bf16 v25, v85, v85, v25
    v_dot2_f32_bf16 v24, v86, s45, v24
    v_dot2_f32_bf16 v25, v86, v86, v25
    v_dot2_f32_bf16 v24, v87, s45, v24
    v_dot2_f32_bf16 v25, v87, v87, v25
    v_dot2_f32_bf16 v24, v88, s45, v24
    v_dot2_f32_bf16 v25, v88, v88, v25
    v_dot2_f32_bf16 v24, v89, s45, v24
    v_dot2_f32_bf16 v25, v89, v89, v25
    v_dot2_f32_bf16 v24, v90, s45, v24
    v_dot2_f32_bf16 v25, v90, v90, v25
    v_dot2_f32_bf16 v24, v91, s45, v24
    v_dot2_f32_bf16 v25, v91, v91, v25
    v_dot2_f32_bf16 v24, v92, s45, v24
    v_dot2_f32_bf16 v25, v92, v92, v25
    v_dot2_f32_bf16 v24, v93, s45, v24
    v_dot2_f32_bf16 v25, v93, v93, v25
    v_dot2_f32_bf16 v24, v94, s45, v24
    v_dot2_f32_bf16 v25, v94, v94, v25
    v_dot2_f32_bf16 v24, v95, s45, v24
    v_dot2_f32_bf16 v25, v95, v95, v25
    v_dot2_f32_bf16 v24, v96, s45, v24
    v_dot2_f32_bf16 v25, v96, v96, v25
    v_dot2_f32_bf16 v24, v97, s45, v24
    v_dot2_f32_bf16 v25, v97, v97, v25
    v_dot2_f32_bf16 v24, v98, s45, v24
    v_dot2_f32_bf16 v25, v98, v98, v25
    v_dot2_f32_bf16 v24, v99, s45, v24
    v_dot2_f32_bf16 v25, v99, v99, v25
    s_waitcnt vmcnt(10)
    v_dot2_f32_bf16 v26, v100, s45, v26
    v_dot2_f32_bf16 v27, v100, v100, v27
    v_dot2_f32_bf16 v26, v101, s45, v26
    v_dot2_f32_bf16 v27, v101, v101, v27
    v_dot2_f32_bf16 v26, v102, s45, v26
    v_dot2_f32_bf16 v27, v102, v102, v27
    v_dot2_f32_bf16 v26, v103, s45, v26
    v_dot2_f32_bf16 v27, v103, v103, v27
    v_dot2_f32_bf16 v26, v104, s45, v26
    v_dot2_f32_bf16 v27, v104, v104, v27
    v_dot2_f32_bf16 v26, v105, s45, v26
    v_dot2_f32_bf16 v27, v105, v105, v27
    v_dot2_f32_bf16 v26, v106, s45, v26
    v_dot2_f32_bf16 v27, v106, v106, v27
    v_dot2_f32_bf16 v26, v107, s45, v26
    v_dot2_f32_bf16 v27, v107, v107, v27
    v_dot2_f32_bf16 v26, v108, s45, v26
    v_dot2_f32_bf16 v27, v108, v108, v27
    v_dot2_f32_bf16 v26, v109, s45, v26
    v_dot2_f32_bf16 v27, v109, v109, v27
    v_dot2_f32_bf16 v26, v110, s45, v26
    v_dot2_f32_bf16 v27, v110, v110, v27
    v_dot2_f32_bf16 v26, v111, s45, v26
    v_dot2_f32_bf16 v27, v111, v111, v27
    v_dot2_f32_bf16 v26, v112, s45, v26
    v_dot2_f32_bf16 v27, v112, v112, v27
    v_dot2_f32_bf16 v26, v113, s45, v26
    v_dot2_f32_bf16 v27, v113, v113, v27
    v_dot2_f32_bf16 v26, v114, s45, v26
    v_dot2_f32_bf16 v27, v114, v114, v27
    v_dot2_f32_bf16 v26, v115, s45, v26
    v_dot2_f32_bf16 v27, v115, v115, v27
    v_dot2_f32_bf16 v26, v116, s45, v26
    v_dot2_f32_bf16 v27, v116, v116, v27
    v_dot2_f32_bf16 v26, v117, s45, v26
    v_dot2_f32_bf16 v27, v117, v117, v27
    v_dot2_f32_bf16 v26, v118, s45, v26
    v_dot2_f32_bf16 v27, v118, v118, v27
    v_dot2_f32_bf16 v26, v119, s45, v26
    v_dot2_f32_bf16 v27, v119, v119, v27
    s_waitcnt vmcnt(5)
    v_dot2_f32_bf16 v28, v120, s45, v28
    v_dot2_f32_bf16 v29, v120, v120, v29
    v_dot2_f32_bf16 v28, v121, s45, v28
    v_dot2_f32_bf16 v29, v121, v121, v29
    v_dot2_f32_bf16 v28, v122, s45, v28
    v_dot2_f32_bf16 v29, v122, v122, v29
    v_dot2_f32_bf16 v28, v123, s45, v28
    v_dot2_f32_bf16 v29, v123, v123, v29
    v_dot2_f32_bf16 v28, v124, s45, v28
    v_dot2_f32_bf16 v29, v124, v124, v29
    v_dot2_f32_bf16 v28, v125, s45, v28
    v_dot2_f32_bf16 v29, v125, v125, v29
    v_dot2_f32_bf16 v28, v126, s45, v28
    v_dot2_f32_bf16 v29, v126, v126, v29
    v_dot2_f32_bf16 v28, v127, s45, v28
    v_dot2_f32_bf16 v29, v127, v127, v29
    v_dot2_f32_bf16 v28, v128, s45, v28
    v_dot2_f32_bf16 v29, v128, v128, v29
    v_dot2_f32_bf16 v28, v129, s45, v28
    v_dot2_f32_bf16 v29, v129, v129, v29
    v_dot2_f32_bf16 v28, v130, s45, v28
    v_dot2_f32_bf16 v29, v130, v130, v29
    v_dot2_f32_bf16 v28, v131, s45, v28
    v_dot2_f32_bf16 v29, v131, v131, v29
    v_dot2_f32_bf16 v28, v132, s45, v28
    v_dot2_f32_bf16 v29, v132, v132, v29
    v_dot2_f32_bf16 v28, v133, s45, v28
    v_dot2_f32_bf16 v29, v133, v133, v29
    v_dot2_f32_bf16 v28, v134, s45, v28
    v_dot2_f32_bf16 v29, v134, v134, v29
    v_dot2_f32_bf16 v28, v135, s45, v28
    v_dot2_f32_bf16 v29, v135, v135, v29
    v_dot2_f32_bf16 v28, v136, s45, v28
    v_dot2_f32_bf16 v29, v136, v136, v29
    v_dot2_f32_bf16 v28, v137, s45, v28
    v_dot2_f32_bf16 v29, v137, v137, v29
    v_dot2_f32_bf16 v28, v138, s45, v28
    v_dot2_f32_bf16 v29, v138, v138, v29
    v_dot2_f32_bf16 v28, v139, s45, v28
    v_dot2_f32_bf16 v29, v139, v139, v29
    s_waitcnt vmcnt(0)
    global_load_dwordx2 v[4:5], v6, s[36:37] sc1
    v_dot2_f32_bf16 v30, v140, s45, v30
    v_dot2_f32_bf16 v31, v140, v140, v31
    v_dot2_f32_bf16 v30, v141, s45, v30
    v_dot2_f32_bf16 v31, v141, v141, v31
    v_dot2_f32_bf16 v30, v142, s45, v30
    v_dot2_f32_bf16 v31, v142, v142, v31
    v_dot2_f32_bf16 v30, v143, s45, v30
    v_dot2_f32_bf16 v31, v143, v143, v31
    v_dot2_f32_bf16 v30, v144, s45, v30
    v_dot2_f32_bf16 v31, v144, v144, v31
    v_dot2_f32_bf16 v30, v145, s45, v30
    v_dot2_f32_bf16 v31, v145, v145, v31
    v_dot2_f32_bf16 v30, v146, s45, v30
    v_dot2_f32_bf16 v31, v146, v146, v31
    v_dot2_f32_bf16 v30, v147, s45, v30
    v_dot2_f32_bf16 v31, v147, v147, v31
    v_dot2_f32_bf16 v30, v148, s45, v30
    v_dot2_f32_bf16 v31, v148, v148, v31
    v_dot2_f32_bf16 v30, v149, s45, v30
    v_dot2_f32_bf16 v31, v149, v149, v31
    v_dot2_f32_bf16 v30, v150, s45, v30
    v_dot2_f32_bf16 v31, v150, v150, v31
    v_dot2_f32_bf16 v30, v151, s45, v30
    v_dot2_f32_bf16 v31, v151, v151, v31
    v_dot2_f32_bf16 v30, v152, s45, v30
    v_dot2_f32_bf16 v31, v152, v152, v31
    v_dot2_f32_bf16 v30, v153, s45, v30
    v_dot2_f32_bf16 v31, v153, v153, v31
    v_dot2_f32_bf16 v30, v154, s45, v30
    v_dot2_f32_bf16 v31, v154, v154, v31
    v_dot2_f32_bf16 v30, v155, s45, v30
    v_dot2_f32_bf16 v31, v155, v155, v31
    v_dot2_f32_bf16 v30, v156, s45, v30
    v_dot2_f32_bf16 v31, v156, v156, v31
    v_dot2_f32_bf16 v30, v157, s45, v30
    v_dot2_f32_bf16 v31, v157, v157, v31
    v_dot2_f32_bf16 v30, v158, s45, v30
    v_dot2_f32_bf16 v31, v158, v158, v31
    v_dot2_f32_bf16 v30, v159, s45, v30
    v_dot2_f32_bf16 v31, v159, v159, v31
    s_nop 2
    v_add_f32_dpp v24, v24, v24 row_ror:8 row_mask:0xf bank_mask:0xf
    v_add_f32_dpp v25, v25, v25 row_ror:8 row_mask:0xf bank_mask:0xf
    v_add_f32_dpp v26, v26, v26 row_ror:8 row_mask:0xf bank_mask:0xf
    v_add_f32_dpp v27, v27, v27 row_ror:8 row_mask:0xf bank_mask:0xf
    v_add_f32_dpp v28, v28, v28 row_ror:8 row_mask:0xf bank_mask:0xf
    v_add_f32_dpp v29, v29, v29 row_ror:8 row_mask:0xf bank_mask:0xf
    v_add_f32_dpp v30, v30, v30 row_ror:8 row_mask:0xf bank_mask:0xf
    v_add_f32_dpp v31, v31, v31 row_ror:8 row_mask:0xf bank_mask:0xf
    v_add_f32_dpp v24, v24, v24 row_ror:4 row_mask:0xf bank_mask:0xf
    v_add_f32_dpp v25, v25, v25 row_ror:4 row_mask:0xf bank_mask:0xf
    v_add_f32_dpp v26, v26, v26 row_ror:4 row_mask:0xf bank_mask:0xf
    v_add_f32_dpp v27, v27, v27 row_ror:4 row_mask:0xf bank_mask:0xf
    v_add_f32_dpp v28, v28, v28 row_ror:4 row_mask:0xf bank_mask:0xf
    v_add_f32_dpp v29, v29, v29 row_ror:4 row_mask:0xf bank_mask:0xf
    v_add_f32_dpp v30, v30, v30 row_ror:4 row_mask:0xf bank_mask:0xf
    v_add_f32_dpp v31, v31, v31 row_ror:4 row_mask:0xf bank_mask:0xf
    v_add_f32_dpp v24, v24, v24 row_ror:2 row_mask:0xf bank_mask:0xf
    v_add_f32_dpp v25, v25, v25 row_ror:2 row_mask:0xf bank_mask:0xf
    v_add_f32_dpp v26, v26, v26 row_ror:2 row_mask:0xf bank_mask:0xf
    v_add_f32_dpp v27, v27, v27 row_ror:2 row_mask:0xf bank_mask:0xf
    v_add_f32_dpp v28, v28, v28 row_ror:2 row_mask:0xf bank_mask:0xf
    v_add_f32_dpp v29, v29, v29 row_ror:2 row_mask:0xf bank_mask:0xf
    v_add_f32_dpp v30, v30, v30 row_ror:2 row_mask:0xf bank_mask:0xf
    v_add_f32_dpp v31, v31, v31 row_ror:2 row_mask:0xf bank_mask:0xf
    v_add_f32_dpp v24, v24, v24 row_ror:1 row_mask:0xf bank_mask:0xf
    v_add_f32_dpp v25, v25, v25 row_ror:1 row_mask:0xf bank_mask:0xf
    v_add_f32_dpp v26, v26, v26 row_ror:1 row_mask:0xf bank_mask:0xf
    v_add_f32_dpp v27, v27, v27 row_ror:1 row_mask:0xf bank_mask:0xf
    v_add_f32_dpp v28, v28, v28 row_ror:1 row_mask:0xf bank_mask:0xf
    v_add_f32_dpp v29, v29, v29 row_ror:1 row_mask:0xf bank_mask:0xf
    v_add_f32_dpp v30, v30, v30 row_ror:1 row_mask:0xf bank_mask:0xf
    v_add_f32_dpp v31, v31, v31 row_ror:1 row_mask:0xf bank_mask:0xf
    v_cmp_eq_u32 vcc, 1, v2
    s_nop 1
    v_cndmask_b32 v24, v24, v26, vcc
    v_cndmask_b32 v25, v25, v27, vcc
    v_cmp_eq_u32 vcc, 2, v2
    s_nop 1
    v_cndmask_b32 v24, v24, v28, vcc
    v_cndmask_b32 v25, v25, v29, vcc
    v_cmp_eq_u32 vcc, 3, v2
    s_nop 1
    v_cndmask_b32 v24, v24, v30, vcc
    v_cndmask_b32 v25, v25, v31, vcc
    v_mul_f32 v24, 0x3acccccd, v24
    v_mul_f32 v25, 0x3acccccd, v25
    v_fma_f32 v25, -v24, v24, v25
    v_max_f32 v25, 0, v25
    v_cvt_pk_bf16_f32 v32, -v24, -v24
    v_cvt_pk_bf16_f32 v25, v25, v25
    v_and_b32 v25, 0xffff0000, v25
    v_add_f32 v25, 0x3727c5ac, v25
    v_cvt_pk_bf16_f32 v25, v25, v25
    v_and_b32 v25, 0xffff0000, v25
    v_sqrt_f32 v25, v25
    v_and_b32 v24, 0xffff0000, v32
    v_cvt_pk_bf16_f32 v33, v25, v25
    v_and_b32 v25, 0xffff0000, v33
    v_rcp_f32 v48, v25
    s_waitcnt vmcnt(0)
    v_cmp_ne_u32 vcc, 0, v4
    s_cbranch_vccnz L_tagok_4
    s_mov_b32 s50, 0
L_tagspin_5:
    s_sleep 2
    global_load_dwordx2 v[4:5], v6, s[36:37] sc1
    s_add_u32 s50, s50, 1
    s_cmp_gt_u32 s50, 0x10000
    s_waitcnt vmcnt(0)
    s_cbranch_scc1 L_tagok_4
    v_cmp_ne_u32 vcc, 0, v4
    s_cbranch_vccz L_tagspin_5
L_tagok_4:
    v_mov_b32 v34, v4
    v_mov_b32 v35, v5
    v_mul_f32 v49, v24, v48
    s_mov_b32 exec_lo, 0x000f000f
    s_mov_b32 exec_hi, 0x000f000f
    buffer_store_dwordx4 v[32:35], v22, s[60:63], 0 offen sc1
    s_mov_b32 s44, 8192
    buffer_store_dword v48, v23, s[52:55], 0 offen sc1
    buffer_store_dword v49, v23, s[52:55], s44 offen sc1
    s_mov_b64 exec, -1
    s_waitcnt vmcnt(0)
    s_lshl_b32 s44, s42, 3
    s_mov_b64 exec, 1
    buffer_store_dwordx2 v[4:5], v6, s[56:59], s44 offen offset:0 sc1
    s_mov_b64 exec, -1
    s_endpgm
L_kc:
    v_mov_b32 v6, 0
    v_mov_b32 v7, 0
    v_mov_b32 v8, 0
    v_mov_b32 v9, 0
    v_mov_b32 v10, 0
    v_mov_b32 v11, 0
    v_mov_b32 v12, 0
    v_mov_b32 v13, 0
    v_mov_b32 v14, 0
    v_mov_b32 v15, 0
    v_mov_b32 v16, 0
    v_mov_b32 v17, 0
    v_mov_b32 v18, 0
    v_mov_b32 v19, 0
    v_mov_b32 v20, 0
    v_mov_b32 v21, 0
    v_mov_b32 v22, 0
    v_mov_b32 v23, 0
    v_mov_b32 v4, 0
    v_mov_b32 v204, 0
    v_mov_b32 v205, 0
    s_mul_i32 s44, s42, 384
    v_lshlrev_b32 v3, 1, v0
    v_add_u32 v3, s44, v3
    s_lshl_b32 s44, s42, 1
    v_mov_b32 v2, s44
    s_waitcnt lgkmcnt(0)
    global_load_short_d16_hi v4, v2, s[22:23]
    global_load_short_d16_hi v6, v3, s[10:11] offset:0
    global_load_short_d16_hi v7, v3, s[12:13] offset:0
    global_load_short_d16_hi v8, v3, s[14:15] offset:0
    global_load_short_d16_hi v9, v3, s[16:17] offset:0
    global_load_short_d16_hi v10, v3, s[18:19] offset:0
    global_load_short_d16_hi v11, v3, s[20:21] offset:0
    global_load_short_d16_hi v12, v3, s[10:11] offset:128
    global_load_short_d16_hi v13, v3, s[12:13] offset:128
    global_load_short_d16_hi v14, v3, s[14:15] offset:128
    global_load_short_d16_hi v15, v3, s[16:17] offset:128
    global_load_short_d16_hi v16, v3, s[18:19] offset:128
    global_load_short_d16_hi v17, v3, s[20:21] offset:128
    global_load_short_d16_hi v18, v3, s[10:11] offset:256
    global_load_short_d16_hi v19, v3, s[12:13] offset:256
    global_load_short_d16_hi v20, v3, s[14:15] offset:256
    global_load_short_d16_hi v21, v3, s[16:17] offset:256
    global_load_short_d16_hi v22, v3, s[18:19] offset:256
    global_load_short_d16_hi v23, v3, s[20:21] offset:256
    global_load_short_d16_hi v204, v2, s[24:25]
    s_setprio 2
    s_add_u32 s52, s38, 0x7ec000
    s_addc_u32 s53, s39, 0
    s_and_b32 s53, s53, 0xffff
    s_mov_b32 s54, 0xb000
    s_mov_b32 s55, 0x00020000
    s_add_u32 s56, s38, 0x800000
    s_addc_u32 s57, s39, 0
    s_and_b32 s57, s57, 0xffff
    s_mov_b32 s58, 0x2a8000
    s_mov_b32 s59, 0x00020000
    s_add_u32 s60, s38, 0xaa8000
    s_addc_u32 s61, s39, 0
    s_and_b32 s61, s61, 0xffff
    s_mov_b32 s62, 0x2a8000
    s_mov_b32 s63, 0x00020000
    s_mul_i32 s45, s42, 4352
    s_lshl_b32 s47, s42, 3
    s_add_u32 s47, s47, 16384
    v_lshlrev_b32 v1, 2, v0
    v_add_u32 v24, s40, v1
    v_add_u32 v25, 1088, v24
    v_add_u32 v26, 2176, v24
    v_add_u32 v27, 3264, v24
    v_add_u32 v28, 4352, v24
    v_add_u32 v29, 5440, v24
    v_add_u32 v30, 6528, v24
    v_add_u32 v31, 7616, v24
    v_add_u32 v32, 8704, v24
    v_add_u32 v33, 9792, v24
    v_add_u32 v34, 10880, v24
    v_add_u32 v35, 11968, v24
    v_add_u32 v36, 13056, v24
    v_add_u32 v37, 14144, v24
    v_add_u32 v38, 15232, v24
    v_add_u32 v39, 16320, v24
    v_and_b32 v1, 31, v0
    v_mul_u32_u24 v5, 272, v1
    v_lshrrev_b32 v1, 5, v0
    v_lshl_add_u32 v5, v1, 4, v5
    v_add_u32 v5, s40, v5
    v_lshlrev_b32 v207, 4, v0
    v_lshlrev_b32 v240, 3, v0
    v_min_u32 v206, 112, v207
    s_lshr_b32 s51, s42, 4
    s_lshl_b32 s51, s51, 7
    s_add_u32 s51, s51, 36864
    s_add_u32 s64, s38, 0x7e8000
    s_addc_u32 s65, s39, 0
    s_and_b32 s65, s65, 0xffff
    s_mov_b32 s66, 0x4000
    s_mov_b32 s67, 0x00020000
    v_mov_b32 v40, 0
    v_mov_b32 v41, 0
    v_mov_b32 v42, 0
    v_mov_b32 v43, 0
    v_mov_b32 v44, 0
    v_mov_b32 v45, 0
    v_mov_b32 v46, 0
    v_mov_b32 v47, 0
    v_mov_b32 v48, 0
    v_mov_b32 v49, 0
    v_mov_b32 v50, 0
    v_mov_b32 v51, 0
    v_mov_b32 v52, 0
    v_mov_b32 v53, 0
    v_mov_b32 v54, 0
    v_mov_b32 v55, 0
    v_mov_b32 v56, 0
    v_mov_b32 v57, 0
    v_mov_b32 v58, 0
    v_mov_b32 v59, 0
    v_mov_b32 v60, 0
    v_mov_b32 v61, 0
    v_mov_b32 v62, 0
    v_mov_b32 v63, 0
    v_mov_b32 v64, 0
    v_mov_b32 v65, 0
    v_mov_b32 v66, 0
    v_mov_b32 v67, 0
    v_mov_b32 v68, 0
    v_mov_b32 v69, 0
    v_mov_b32 v70, 0
    v_mov_b32 v71, 0
    v_mov_b32 v72, 0
    v_mov_b32 v73, 0
    v_mov_b32 v74, 0
    v_mov_b32 v75, 0
    v_mov_b32 v76, 0
    v_mov_b32 v77, 0
    v_mov_b32 v78, 0
    v_mov_b32 v79, 0
    v_mov_b32 v80, 0
    v_mov_b32 v81, 0
    v_mov_b32 v82, 0
    v_mov_b32 v83, 0
    v_mov_b32 v84, 0
    v_mov_b32 v85, 0
    v_mov_b32 v86, 0
    v_mov_b32 v87, 0
    v_mov_b32 v88, 0
    v_mov_b32 v89, 0
    v_mov_b32 v90, 0
    v_mov_b32 v91, 0
    v_mov_b32 v92, 0
    v_mov_b32 v93, 0
    v_mov_b32 v94, 0
    v_mov_b32 v95, 0
    v_mov_b32 v96, 0
    v_mov_b32 v97, 0
    v_mov_b32 v98, 0
    v_mov_b32 v99, 0
    v_mov_b32 v100, 0
    v_mov_b32 v101, 0
    v_mov_b32 v102, 0
    v_mov_b32 v103, 0
    v_mov_b32 v104, 0
    v_mov_b32 v105, 0
    v_mov_b32 v106, 0
    v_mov_b32 v107, 0
    v_mov_b32 v108, 0
    v_mov_b32 v109, 0
    v_mov_b32 v110, 0
    v_mov_b32 v111, 0
    v_mov_b32 v112, 0
    v_mov_b32 v113, 0
    v_mov_b32 v114, 0
    v_mov_b32 v115, 0
    v_mov_b32 v116, 0
    v_mov_b32 v117, 0
    v_mov_b32 v118, 0
    v_mov_b32 v119, 0
    s_waitcnt vmcnt(19)
    v_mul_f32 v192, 0x3fb8aa3b, v4
    s_mov_b32 s44, 0x3fb8aa3b
    v_fma_f32 v193, v4, s44, -v192
    v_fmamk_f32 v193, v4, 0x32a57060, v193
    v_exp_f32 v192, v192
    v_mul_f32 v193, 0x3f317218, v193
    v_fma_f32 v192, v192, v193, v192
    v_cvt_pk_bf16_f32 v4, v192, v192
    v_and_b32 v4, 0xffff0000, v4
    s_waitcnt vmcnt(0)
    s_mov_b32 s46, 0
L_kgen_6:
    v_mul_f32 v192, v4, v6
    v_mul_f32 v193, v4, v7
    v_mul_f32 v192, 0x3fb8aa3b, v192
    v_mul_f32 v193, 0x3e22f983, v193
    v_mul_f32 v172, v4, v8
    v_mul_f32 v174, v4, v9
    v_mul_f32 v120, v10, v172
    v_mul_f32 v130, v10, v174
    v_fma_f32 v120, -v11, v174, v120
    v_fmac_f32 v130, v11, v172
    v_exp_f32 v194, v192
    v_rndne_f32 v196, v193
    v_sub_f32 v195, v193, v196
    v_mul_f32 v197, 0x41000000, v192
    v_mul_f32 v198, 0x41000000, v193
    v_exp_f32 v197, v197
    v_rndne_f32 v199, v198
    v_sub_f32 v198, v198, v199
    v_mul_f32 v200, 0x43800000, v192
    v_mul_f32 v201, 0x43800000, v193
    v_exp_f32 v200, v200
    v_rndne_f32 v202, v201
    v_sub_f32 v201, v201, v202
    v_mov_b32 v6, v12
    v_mov_b32 v7, v13
    v_mov_b32 v8, v14
    v_mov_b32 v9, v15
    v_mov_b32 v10, v16
    v_mov_b32 v11, v17
    v_mov_b32 v12, v18
    v_mov_b32 v13, v19
    v_mov_b32 v14, v20
    v_mov_b32 v15, v21
    v_mov_b32 v16, v22
    v_mov_b32 v17, v23
    s_waitcnt lgkmcnt(0)
    v_mfma_f32_32x32x16_bf16 v[40:55], v[56:59], v[88:91], v[40:55]
    v_cos_f32 v176, v195
    v_sin_f32 v178, v195
    v_cos_f32 v157, v198
    v_sin_f32 v159, v198
    v_cos_f32 v140, v201
    v_sin_f32 v148, v201
    v_mov_b32 v156, 1.0
    v_mov_b32 v158, 0
    v_mul_f32 v176, v176, v194
    v_mul_f32 v178, v178, v194
    v_mul_f32 v157, v157, v197
    v_mul_f32 v159, v159, v197
    v_mfma_f32_32x32x16_bf16 v[40:55], v[60:63], v[92:95], v[40:55]
    v_mul_f32 v140, v140, v200
    v_mul_f32 v148, v148, v200
    v_mul_f32 v164, v157, v157
    v_mul_f32 v166, v157, v159
    v_fma_f32 v164, -v159, v159, v164
    v_add_f32 v166, v166, v166
    v_mul_f32 v160, v176, v176
    v_mul_f32 v162, v176, v178
    v_fma_f32 v160, -v178, v178, v160
    v_add_f32 v162, v162, v162
    v_mul_f32 v141, v140, v140
    v_mul_f32 v149, v140, v148
    v_mfma_f32_32x32x16_bf16 v[40:55], v[64:67], v[96:99], v[40:55]
    v_fma_f32 v141, -v148, v148, v141
    v_add_f32 v149, v149, v149
    v_mul_f32 v121, v120, v176
    v_mul_f32 v131, v120, v178
    v_fma_f32 v121, -v130, v178, v121
    v_fmac_f32 v131, v130, v176
    v_cvt_pk_bf16_f32 v184, v156, v158
    v_cvt_pk_bf16_f32 v185, v157, v159
    v_mul_f32 v172, v158, v166
    v_mul_f32 v158, v158, v164
    v_mul_f32 v173, v159, v166
    v_mul_f32 v159, v159, v164
    v_mfma_f32_32x32x16_bf16 v[40:55], v[68:71], v[100:103], v[40:55]
    v_mul_f32 v122, v120, v160
    v_mul_f32 v132, v120, v162
    v_mul_f32 v123, v121, v160
    v_mul_f32 v133, v121, v162
    ds_write2_b32 v32, v184, v185 offset0:0 offset1:68
    v_fmac_f32 v158, v156, v166
    v_fma_f32 v156, v156, v164, -v172
    v_fmac_f32 v159, v157, v166
    v_fma_f32 v157, v157, v164, -v173
    v_fma_f32 v122, -v130, v162, v122
    v_fmac_f32 v132, v130, v160
    v_fma_f32 v123, -v131, v162, v123
    v_mfma_f32_32x32x16_bf16 v[40:55], v[72:75], v[104:107], v[40:55]
    v_fmac_f32 v133, v131, v160
    v_cvt_pk_bf16_f32 v186, v156, v158
    v_cvt_pk_bf16_f32 v187, v157, v159
    v_mul_f32 v172, v158, v166
    v_mul_f32 v158, v158, v164
    v_mul_f32 v173, v159, v166
    v_mul_f32 v159, v159, v164
    v_mul_f32 v124, v122, v160
    v_mul_f32 v134, v122, v162
    v_mul_f32 v125, v123, v160
    v_mul_f32 v135, v123, v162
    ds_write2_b32 v32, v186, v187 offset0:136 offset1:204
    v_mfma_f32_32x32x16_bf16 v[40:55], v[76:79], v[108:111], v[40:55]
    v_fmac_f32 v158, v156, v166
    v_fma_f32 v156, v156, v164, -v172
    v_fmac_f32 v159, v157, v166
    v_fma_f32 v157, v157, v164, -v173
    v_fma_f32 v124, -v132, v162, v124
    v_fmac_f32 v134, v132, v160
    v_fma_f32 v125, -v133, v162, v125
    v_fmac_f32 v135, v133, v160
    v_cvt_pk_bf16_f32 v184, v156, v158
    v_cvt_pk_bf16_f32 v185, v157, v159
    v_mul_f32 v172, v158, v166
    v_mul_f32 v158, v158, v164
    v_mfma_f32_32x32x16_bf16 v[40:55], v[80:83], v[112:115], v[40:55]
    v_mul_f32 v173, v159, v166
    v_mul_f32 v159, v159, v164
    v_mul_f32 v126, v124, v160
    v_mul_f32 v136, v124, v162
    v_mul_f32 v127, v125, v160
    v_mul_f32 v137, v125, v162
    ds_write2_b32 v33, v184, v185 offset0:0 offset1:68
    v_fmac_f32 v158, v156, v166
    v_fma_f32 v156, v156, v164, -v172
    v_fmac_f32 v159, v157, v166
    v_fma_f32 v157, v157, v164, -v173
    v_fma_f32 v126, -v134, v162, v126
    v_mfma_f32_32x32x16_bf16 v[40:55], v[84:87], v[116:119], v[40:55]
    v_fmac_f32 v136, v134, v160
    v_fma_f32 v127, -v135, v162, v127
    v_fmac_f32 v137, v135, v160
    v_cvt_pk_bf16_f32 v186, v156, v158
    v_cvt_pk_bf16_f32 v187, v157, v159
    v_mul_f32 v172, v158, v166
    v_mul_f32 v158, v158, v164
    v_mul_f32 v173, v159, v166
    v_mul_f32 v159, v159, v164
    v_mul_f32 v128, v126, v160
    v_mul_f32 v138, v126, v162
    ds_write2_b32 v33, v186, v187 offset0:136 offset1:204
    v_fmac_f32 v158, v156, v166
    v_fma_f32 v156, v156, v164, -v172
    v_fmac_f32 v159, v157, v166
    v_fma_f32 v157, v157, v164, -v173
    v_fma_f32 v128, -v136, v162, v128
    v_fmac_f32 v138, v136, v160
    v_cvt_pk_bf16_f32 v184, v156, v158
    v_cvt_pk_bf16_f32 v185, v157, v159
    v_mul_f32 v172, v158, v166
    v_mul_f32 v158, v158, v164
    v_mul_f32 v173, v159, v166
    v_mul_f32 v159, v159, v164
    v_mul_f32 v142, v140, v141
    v_mul_f32 v150, v140, v149
    v_mul_f32 v143, v141, v141
    v_mul_f32 v151, v141, v149
    ds_write2_b32 v34, v184, v185 offset0:0 offset1:68
    v_fmac_f32 v158, v156, v166
    v_fma_f32 v156, v156, v164, -v172
    v_fmac_f32 v159, v157, v166
    v_fma_f32 v157, v157, v164, -v173
    v_fma_f32 v142, -v148, v149, v142
    v_fmac_f32 v150, v148, v141
    v_fma_f32 v143, -v149, v149, v143
    v_fmac_f32 v151, v149, v141
    v_cvt_pk_bf16_f32 v186, v156, v158
    v_cvt_pk_bf16_f32 v187, v157, v159
    v_mul_f32 v172, v158, v166
    v_mul_f32 v158, v158, v164
    v_mul_f32 v173, v159, v166
    v_mul_f32 v159, v159, v164
    v_mul_f32 v144, v142, v141
    v_mul_f32 v152, v142, v149
    v_mul_f32 v145, v143, v141
    v_mul_f32 v153, v143, v149
    ds_write2_b32 v34, v186, v187 offset0:136 offset1:204
    v_fmac_f32 v158, v156, v166
    v_fma_f32 v156, v156, v164, -v172
    v_fmac_f32 v159, v157, v166
    v_fma_f32 v157, v157, v164, -v173
    v_fma_f32 v144, -v150, v149, v144
    v_fmac_f32 v152, v150, v141
    v_fma_f32 v145, -v151, v149, v145
    v_fmac_f32 v153, v151, v141
    v_cvt_pk_bf16_f32 v184, v156, v158
    v_cvt_pk_bf16_f32 v185, v157, v159
    v_mul_f32 v172, v158, v166
    v_mul_f32 v158, v158, v164
    v_mul_f32 v173, v159, v166
    v_mul_f32 v159, v159, v164
    v_mul_f32 v146, v144, v141
    v_mul_f32 v154, v144, v149
    ds_write2_b32 v35, v184, v185 offset0:0 offset1:68
    v_fmac_f32 v158, v156, v166
    v_fma_f32 v156, v156, v164, -v172
    v_fmac_f32 v159, v157, v166
    v_fma_f32 v157, v157, v164, -v173
    v_fma_f32 v146, -v152, v149, v146
    v_fmac_f32 v154, v152, v141
    v_cvt_pk_bf16_f32 v186, v156, v158
    v_cvt_pk_bf16_f32 v187, v157, v159
    v_mul_f32 v172, v158, v166
    v_mul_f32 v158, v158, v164
    v_mul_f32 v173, v159, v166
    v_mul_f32 v159, v159, v164
    ds_write2_b32 v35, v186, v187 offset0:136 offset1:204
    v_fmac_f32 v158, v156, v166
    v_fma_f32 v156, v156, v164, -v172
    v_fmac_f32 v159, v157, v166
    v_fma_f32 v157, v157, v164, -v173
    v_cvt_pk_bf16_f32 v184, v156, v158
    v_cvt_pk_bf16_f32 v185, v157, v159
    v_mul_f32 v172, v158, v166
    v_mul_f32 v158, v158, v164
    v_mul_f32 v173, v159, v166
    v_mul_f32 v159, v159, v164
    ds_write2_b32 v36, v184, v185 offset0:0 offset1:68
    v_fmac_f32 v158, v156, v166
    v_fma_f32 v156, v156, v164, -v172
    v_fmac_f32 v159, v157, v166
    v_fma_f32 v157, v157, v164, -v173
    v_cvt_pk_bf16_f32 v186, v156, v158
    v_cvt_pk_bf16_f32 v187, v157, v159
    v_mul_f32 v172, v158, v166
    v_mul_f32 v158, v158, v164
    v_mul_f32 v173, v159, v166
    v_mul_f32 v159, v159, v164
    ds_write2_b32 v36, v186, v187 offset0:136 offset1:204
    v_fmac_f32 v158, v156, v166
    v_fma_f32 v156, v156, v164, -v172
    v_fmac_f32 v159, v157, v166
    v_fma_f32 v157, v157, v164, -v173
    v_cvt_pk_bf16_f32 v184, v156, v158
    v_cvt_pk_bf16_f32 v185, v157, v159
    v_mul_f32 v172, v158, v166
    v_mul_f32 v158, v158, v164
    v_mul_f32 v173, v159, v166
    v_mul_f32 v159, v159, v164
    ds_write2_b32 v37, v184, v185 offset0:0 offset1:68
    v_fmac_f32 v158, v156, v166
    v_fma_f32 v156, v156, v164, -v172
    v_fmac_f32 v159, v157, v166
    v_fma_f32 v157, v157, v164, -v173
    v_cvt_pk_bf16_f32 v186, v156, v158
    v_cvt_pk_bf16_f32 v187, v157, v159
    v_mul_f32 v172, v158, v166
    v_mul_f32 v158, v158, v164
    v_mul_f32 v173, v159, v166
    v_mul_f32 v159, v159, v164
    ds_write2_b32 v37, v186, v187 offset0:136 offset1:204
    v_fmac_f32 v158, v156, v166
    v_fma_f32 v156, v156, v164, -v172
    v_fmac_f32 v159, v157, v166
    v_fma_f32 v157, v157, v164, -v173
    v_cvt_pk_bf16_f32 v184, v156, v158
    v_cvt_pk_bf16_f32 v185, v157, v159
    v_mul_f32 v172, v158, v166
    v_mul_f32 v158, v158, v164
    v_mul_f32 v173, v159, v166
    v_mul_f32 v159, v159, v164
    ds_write2_b32 v38, v184, v185 offset0:0 offset1:68
    v_fmac_f32 v158, v156, v166
    v_fma_f32 v156, v156, v164, -v172
    v_fmac_f32 v159, v157, v166
    v_fma_f32 v157, v157, v164, -v173
    v_cvt_pk_bf16_f32 v186, v156, v158
    v_cvt_pk_bf16_f32 v187, v157, v159
    v_mul_f32 v172, v158, v166
    v_mul_f32 v158, v158, v164
    v_mul_f32 v173, v159, v166
    v_mul_f32 v159, v159, v164
    ds_write2_b32 v38, v186, v187 offset0:136 offset1:204
    v_fmac_f32 v158, v156, v166
    v_fma_f32 v156, v156, v164, -v172
    v_fmac_f32 v159, v157, v166
    v_fma_f32 v157, v157, v164, -v173
    v_cvt_pk_bf16_f32 v184, v156, v158
    v_cvt_pk_bf16_f32 v185, v157, v159
    v_mul_f32 v172, v158, v166
    v_mul_f32 v158, v158, v164
    v_mul_f32 v173, v159, v166
    v_mul_f32 v159, v159, v164
    ds_write2_b32 v39, v184, v185 offset0:0 offset1:68
    v_fmac_f32 v158, v156, v166
    v_fma_f32 v156, v156, v164, -v172
    v_fmac_f32 v159, v157, v166
    v_fma_f32 v157, v157, v164, -v173
    v_cvt_pk_bf16_f32 v186, v156, v158
    v_cvt_pk_bf16_f32 v187, v157, v159
    ds_write2_b32 v39, v186, v187 offset0:136 offset1:204
    v_cvt_pk_bf16_f32 v188, v120, -v130
    v_cvt_pk_bf16_f32 v189, v121, -v131
    ds_write2_b32 v24, v188, v189 offset0:0 offset1:68
    v_cvt_pk_bf16_f32 v190, v122, -v132
    v_cvt_pk_bf16_f32 v191, v123, -v133
    ds_write2_b32 v24, v190, v191 offset0:136 offset1:204
    v_cvt_pk_bf16_f32 v188, v124, -v134
    v_cvt_pk_bf16_f32 v189, v125, -v135
    ds_write2_b32 v26, v188, v189 offset0:0 offset1:68
    v_cvt_pk_bf16_f32 v190, v126, -v136
    v_cvt_pk_bf16_f32 v191, v127, -v137
    ds_write2_b32 v26, v190, v191 offset0:136 offset1:204
    v_cvt_pk_bf16_f32 v192, v128, -v138
    v_mul_f32 v180, v120, v140
    v_mul_f32 v182, v120, v148
    v_mul_f32 v181, v120, v141
    v_mul_f32 v183, v120, v149
    v_fma_f32 v180, -v130, v148, v180
    v_fmac_f32 v182, v130, v140
    v_fma_f32 v181, -v130, v149, v181
    v_fmac_f32 v183, v130, v141
    v_cvt_pk_bf16_f32 v193, v180, -v182
    v_cvt_pk_bf16_f32 v194, v181, -v183
    ds_write2_b32 v25, v193, v193 offset0:0 offset1:68
    ds_write2_b32 v28, v192, v194 offset0:0 offset1:68
    v_mul_f32 v180, v122, v140
    v_mul_f32 v182, v122, v148
    v_mul_f32 v181, v124, v140
    v_mul_f32 v183, v124, v148
    v_fma_f32 v180, -v132, v148, v180
    v_fmac_f32 v182, v132, v140
    v_fma_f32 v181, -v134, v148, v181
    v_fmac_f32 v183, v134, v140
    v_cvt_pk_bf16_f32 v195, v180, -v182
    v_cvt_pk_bf16_f32 v196, v181, -v183
    ds_write2_b32 v25, v195, v196 offset0:136 offset1:204
    ds_write2_b32 v27, v196, v196 offset0:0 offset1:68
    v_mul_f32 v180, v126, v140
    v_mul_f32 v182, v126, v148
    v_mul_f32 v181, v128, v140
    v_mul_f32 v183, v128, v148
    v_fma_f32 v180, -v136, v148, v180
    v_fmac_f32 v182, v136, v140
    v_fma_f32 v181, -v138, v148, v181
    v_fmac_f32 v183, v138, v140
    v_cvt_pk_bf16_f32 v197, v180, -v182
    v_cvt_pk_bf16_f32 v198, v181, -v183
    ds_write2_b32 v27, v197, v198 offset0:136 offset1:204
    v_mul_f32 v180, v124, v141
    v_mul_f32 v182, v124, v149
    v_mul_f32 v181, v128, v141
    v_mul_f32 v183, v128, v149
    v_fma_f32 v180, -v134, v149, v180
    v_fmac_f32 v182, v134, v141
    v_fma_f32 v181, -v138, v149, v181
    v_fmac_f32 v183, v138, v141
    v_cvt_pk_bf16_f32 v199, v180, -v182
    v_cvt_pk_bf16_f32 v200, v181, -v183
    ds_write2_b32 v28, v199, v200 offset0:136 offset1:204
    v_mul_f32 v180, v120, v142
    v_mul_f32 v182, v120, v150
    v_fma_f32 v180, -v130, v150, v180
    v_fmac_f32 v182, v130, v142
    v_cvt_pk_bf16_f32 v201, v180, -v182
    ds_write2_b32 v29, v198, v201 offset0:0 offset1:68
    v_mul_f32 v180, v124, v142
    v_mul_f32 v182, v124, v150
    v_mul_f32 v181, v128, v142
    v_mul_f32 v183, v128, v150
    v_fma_f32 v180, -v134, v150, v180
    v_fmac_f32 v182, v134, v142
    v_fma_f32 v181, -v138, v150, v181
    v_fmac_f32 v183, v138, v142
    v_cvt_pk_bf16_f32 v202, v180, -v182
    v_cvt_pk_bf16_f32 v203, v181, -v183
    ds_write2_b32 v29, v202, v203 offset0:136 offset1:204
    v_mul_f32 v180, v120, v143
    v_mul_f32 v182, v120, v151
    v_mul_f32 v181, v128, v143
    v_mul_f32 v183, v128, v151
    v_fma_f32 v180, -v130, v151, v180
    v_fmac_f32 v182, v130, v143
    v_fma_f32 v181, -v138, v151, v181
    v_fmac_f32 v183, v138, v143
    v_cvt_pk_bf16_f32 v184, v180, -v182
    v_cvt_pk_bf16_f32 v185, v181, -v183
    ds_write2_b32 v30, v184, v185 offset0:0 offset1:68
    v_mul_f32 v180, v120, v144
    v_mul_f32 v182, v120, v152
    v_mul_f32 v181, v128, v144
    v_mul_f32 v183, v128, v152
    v_fma_f32 v180, -v130, v152, v180
    v_fmac_f32 v182, v130, v144
    v_fma_f32 v181, -v138, v152, v181
    v_fmac_f32 v183, v138, v144
    v_cvt_pk_bf16_f32 v186, v180, -v182
    v_cvt_pk_bf16_f32 v187, v181, -v183
    ds_write2_b32 v30, v186, v187 offset0:136 offset1:204
    v_mul_f32 v180, v120, v145
    v_mul_f32 v182, v120, v153
    v_mul_f32 v181, v128, v145
    v_mul_f32 v183, v128, v153
    v_fma_f32 v180, -v130, v153, v180
    v_fmac_f32 v182, v130, v145
    v_fma_f32 v181, -v138, v153, v181
    v_fmac_f32 v183, v138, v145
    v_cvt_pk_bf16_f32 v188, v180, -v182
    v_cvt_pk_bf16_f32 v189, v181, -v183
    ds_write2_b32 v31, v188, v189 offset0:0 offset1:68
    v_mul_f32 v180, v120, v146
    v_mul_f32 v182, v120, v154
    v_mul_f32 v181, v128, v146
    v_mul_f32 v183, v128, v154
    v_fma_f32 v180, -v130, v154, v180
    v_fmac_f32 v182, v130, v146
    v_fma_f32 v181, -v138, v154, v181
    v_fmac_f32 v183, v138, v146
    v_cvt_pk_bf16_f32 v190, v180, -v182
    v_cvt_pk_bf16_f32 v191, v181, -v183
    ds_write2_b32 v31, v190, v191 offset0:136 offset1:204
    ds_read_b128 v[56:59], v5 offset:0
    ds_read_b128 v[88:91], v5 offset:8704
    ds_read_b128 v[60:63], v5 offset:32
    ds_read_b128 v[92:95], v5 offset:8736
    ds_read_b128 v[64:67], v5 offset:64
    ds_read_b128 v[96:99], v5 offset:8768
    ds_read_b128 v[68:71], v5 offset:96
    ds_read_b128 v[100:103], v5 offset:8800
    ds_read_b128 v[72:75], v5 offset:128
    ds_read_b128 v[104:107], v5 offset:8832
    ds_read_b128 v[76:79], v5 offset:160
    ds_read_b128 v[108:111], v5 offset:8864
    ds_read_b128 v[80:83], v5 offset:192
    ds_read_b128 v[112:115], v5 offset:8896
    ds_read_b128 v[84:87], v5 offset:224
    ds_read_b128 v[116:119], v5 offset:8928
    s_add_u32 s46, s46, 1
    s_cmp_lt_u32 s46, 3
    s_cbranch_scc1 L_kgen_6
    v_sub_u32 v192, 1008, v207
    v_add_u32 v192, s40, v192
    v_and_b32 v193, 0x1f0, v207
    v_add_u32 v195, s40, v193
    v_lshrrev_b32 v2, 5, v0
    v_lshl_add_u32 v193, v2, 10, v193
    v_sub_u32 v193, 1520, v193
    v_add_u32 v193, s40, v193
    v_cmp_eq_u32 vcc, 0, v0
    v_and_b32 v1, 1, v0
    v_lshlrev_b32 v194, 4, v1
    v_cndmask_b32 v204, 0, v204, vcc
    v_bfe_u32 v2, v0, 1, 1
    v_mul_u32_u24 v2, 4160, v2
    v_add3_u32 v194, v194, v2, s40
    s_waitcnt lgkmcnt(0)
    v_mfma_f32_32x32x16_bf16 v[40:55], v[56:59], v[88:91], v[40:55]
    v_mfma_f32_32x32x16_bf16 v[40:55], v[60:63], v[92:95], v[40:55]
    v_mfma_f32_32x32x16_bf16 v[40:55], v[64:67], v[96:99], v[40:55]
    v_mfma_f32_32x32x16_bf16 v[40:55], v[68:71], v[100:103], v[40:55]
    v_mfma_f32_32x32x16_bf16 v[40:55], v[72:75], v[104:107], v[40:55]
    v_mfma_f32_32x32x16_bf16 v[40:55], v[76:79], v[108:111], v[40:55]
    v_mfma_f32_32x32x16_bf16 v[40:55], v[80:83], v[112:115], v[40:55]
    v_mfma_f32_32x32x16_bf16 v[40:55], v[84:87], v[116:119], v[40:55]
    v_mov_b32 v32, 0
    v_mov_b32 v33, 0
    v_mov_b32 v34, 0
    v_mov_b32 v35, 0
    ds_write_b128 v195, v[32:35] offset:9216
    v_and_b32 v1, 15, v0
    v_lshrrev_b32 v2, 4, v0
    v_lshlrev_b32 v24, 3, v2
    v_sub_u32 v24, v24, v1
    v_lshlrev_b32 v24, 1, v24
    v_and_b32 v25, 1, v0
    v_cmp_eq_u32 vcc, 1, v25
    v_xor_b32 v25, 1, v25
    v_mul_u32_u24 v25, 4162, v25
    v_add3_u32 v24, v24, v25, s40
    v_add_u32 v27, 414, v24
    v_add_u32 v26, 1438, v24
    v_add_u32 v25, 2462, v24
    v_add_u32 v24, 3486, v24
    v_lshlrev_b32 v28, 5, v1
    v_lshl_add_u32 v28, v2, 4, v28
    v_add_u32 v28, s40, v28
    v_add_u32 v28, 9632, v28
    v_add_f32 v40, v40, v204
    v_cvt_pk_bf16_f32 v56, v47, v46
    v_cvt_pk_bf16_f32 v57, v45, v44
    v_cvt_pk_bf16_f32 v58, v43, v42
    v_cvt_pk_bf16_f32 v59, v41, v40
    ds_write_b128 v192, v[56:59] offset:3072
    v_cvt_pk_bf16_f32 v60, v48, v47
    v_cvt_pk_bf16_f32 v61, v46, v45
    v_cvt_pk_bf16_f32 v62, v44, v43
    v_cvt_pk_bf16_f32 v63, v42, v41
    ds_write_b128 v192, v[60:63] offset:7232
    v_cvt_pk_bf16_f32 v64, v51, v51
    v_cvt_pk_bf16_f32 v65, v50, v50
    v_cvt_pk_bf16_f32 v66, v50, v49
    v_cvt_pk_bf16_f32 v67, v49, v49
    ds_write_b128 v192, v[64:67] offset:2048
    v_cvt_pk_bf16_f32 v68, v51, v51
    v_cvt_pk_bf16_f32 v69, v51, v50
    v_cvt_pk_bf16_f32 v70, v50, v50
    v_cvt_pk_bf16_f32 v71, v49, v49
    ds_write_b128 v192, v[68:71] offset:6208
    v_cndmask_b32 v196, v52, v53, vcc
    v_cvt_pk_bf16_f32 v72, v53, v53
    v_cvt_pk_bf16_f32 v73, v53, v196
    v_cvt_pk_bf16_f32 v74, v52, v52
    v_cvt_pk_bf16_f32 v75, v52, v52
    ds_write_b128 v193, v[72:75] offset:512
    v_cvt_pk_bf16_f32 v76, v53, v53
    v_cvt_pk_bf16_f32 v77, v53, v53
    v_cvt_pk_bf16_f32 v78, v196, v52
    v_cvt_pk_bf16_f32 v79, v52, v52
    ds_write_b128 v193, v[76:79] offset:4672
    v_cndmask_b32 v197, v54, v55, vcc
    v_cvt_pk_bf16_f32 v80, v55, v55
    v_cvt_pk_bf16_f32 v81, v55, v197
    v_cvt_pk_bf16_f32 v82, v54, v54
    v_cvt_pk_bf16_f32 v83, v54, v54
    ds_write_b128 v193, v[80:83] offset:0
    v_cvt_pk_bf16_f32 v84, v55, v55
    v_cvt_pk_bf16_f32 v85, v55, v55
    v_cvt_pk_bf16_f32 v86, v197, v54
    v_cvt_pk_bf16_f32 v87, v54, v54
    ds_write_b128 v193, v[84:87] offset:4160
    v_readlane_b32 s44, v40, 0
    v_and_b32 v1, 3, v0
    v_cmp_eq_u32 vcc, 2, v1
    v_cvt_pk_bf16_f32 v2, s44, 0
    s_nop 0
    v_cndmask_b32 v32, 0, v2, vcc
    ds_write_b128 v194, v[32:35] offset:4096
    s_lshl_b32 s44, s3, 2
    s_add_u32 s44, s44, 159744
    v_mov_b32 v1, s44
    s_mov_b32 s46, 0
L_gate_7:
    ds_read_b32 v2, v1
    s_add_u32 s46, s46, 1
    s_cmp_gt_u32 s46, 0x40000
    s_waitcnt lgkmcnt(0)
    s_cbranch_scc1 L_gateok_8
    v_cmp_le_u32 vcc, 18, v2
    s_cbranch_vccnz L_gateok_8
    s_sleep 2
    s_branch L_gate_7
L_gateok_8:
    global_load_dwordx2 v[242:243], v205, s[36:37] sc1
    buffer_load_dwordx4 v[244:247], v207, s[52:55], 0 offen offset:0 sc1
    buffer_load_dwordx4 v[248:251], v206, s[52:55], s51 offen offset:0 sc1
    s_waitcnt vmcnt(2)
    v_cmp_ne_u32 vcc, 0, v242
    s_cbranch_vccnz L_tagok_9
    s_mov_b32 s50, 0
L_tagspin_10:
    s_sleep 2
    global_load_dwordx2 v[242:243], v205, s[36:37] sc1
    s_add_u32 s50, s50, 1
    s_cmp_gt_u32 s50, 0x10000
    s_waitcnt vmcnt(0)
    s_cbranch_scc1 L_tagok_9
    v_cmp_ne_u32 vcc, 0, v242
    s_cbranch_vccz L_tagspin_10
L_tagok_9:
    s_waitcnt vmcnt(1)
    s_mov_b32 s50, 0
    s_branch L_pchk_13
L_pspin_12:
    s_sleep 16
    buffer_load_dwordx4 v[244:247], v207, s[52:55], 0 offen offset:0 sc1
    s_add_u32 s50, s50, 1
    s_cmp_gt_u32 s50, 0x10000
    s_waitcnt vmcnt(0)
    s_cbranch_scc1 L_pok_11
L_pchk_13:
    v_cmp_ne_u64 vcc, v[244:245], v[242:243]
    v_cmp_ne_u64 s[48:49], v[246:247], v[242:243]
    s_or_b64 vcc, vcc, s[48:49]
    s_cbranch_scc1 L_pspin_12
L_pok_11:
    s_waitcnt vmcnt(0)
    s_mov_b32 s50, 0
    s_branch L_pchk_16
L_pspin_15:
    s_sleep 16
    buffer_load_dwordx4 v[248:251], v206, s[52:55], s51 offen offset:0 sc1
    s_add_u32 s50, s50, 1
    s_cmp_gt_u32 s50, 0x10000
    s_waitcnt vmcnt(0)
    s_cbranch_scc1 L_pok_14
L_pchk_16:
    v_cmp_ne_u64 vcc, v[248:249], v[242:243]
    v_cmp_ne_u64 s[48:49], v[250:251], v[242:243]
    s_or_b64 vcc, vcc, s[48:49]
    s_cbranch_scc1 L_pspin_15
L_pok_14:
    buffer_load_dwordx2 v[120:121], v240, s[56:59], s45 offen offset:0 sc1
    s_mov_b32 s44, 0
    buffer_load_dwordx4 v[136:139], v207, s[64:67], s44 offen sc1
    s_mov_b32 s44, 8192
    buffer_load_dwordx4 v[140:143], v207, s[64:67], s44 offen sc1
    buffer_load_dwordx2 v[122:123], v240, s[56:59], s45 offen offset:512 sc1
    s_mov_b32 s44, 1024
    buffer_load_dwordx4 v[144:147], v207, s[64:67], s44 offen sc1
    s_mov_b32 s44, 9216
    buffer_load_dwordx4 v[148:151], v207, s[64:67], s44 offen sc1
    buffer_load_dwordx2 v[124:125], v240, s[56:59], s45 offen offset:1024 sc1
    s_mov_b32 s44, 2048
    buffer_load_dwordx4 v[152:155], v207, s[64:67], s44 offen sc1
    s_mov_b32 s44, 10240
    buffer_load_dwordx4 v[156:159], v207, s[64:67], s44 offen sc1
    buffer_load_dwordx2 v[126:127], v240, s[56:59], s45 offen offset:1536 sc1
    s_mov_b32 s44, 3072
    buffer_load_dwordx4 v[160:163], v207, s[64:67], s44 offen sc1
    s_mov_b32 s44, 11264
    buffer_load_dwordx4 v[164:167], v207, s[64:67], s44 offen sc1
    buffer_load_dwordx2 v[128:129], v240, s[56:59], s45 offen offset:2048 sc1
    s_mov_b32 s44, 4096
    buffer_load_dwordx4 v[168:171], v207, s[64:67], s44 offen sc1
    s_mov_b32 s44, 12288
    buffer_load_dwordx4 v[172:175], v207, s[64:67], s44 offen sc1
    buffer_load_dwordx2 v[130:131], v240, s[56:59], s45 offen offset:2560 sc1
    s_mov_b32 s44, 5120
    buffer_load_dwordx4 v[176:179], v207, s[64:67], s44 offen sc1
    s_mov_b32 s44, 13312
    buffer_load_dwordx4 v[180:183], v207, s[64:67], s44 offen sc1
    buffer_load_dwordx2 v[132:133], v240, s[56:59], s45 offen offset:3072 sc1
    s_mov_b32 s44, 6144
    buffer_load_dwordx4 v[184:187], v207, s[64:67], s44 offen sc1
    s_mov_b32 s44, 14336
    buffer_load_dwordx4 v[188:191], v207, s[64:67], s44 offen sc1
    buffer_load_dwordx2 v[134:135], v240, s[56:59], s45 offen offset:3584 sc1
    s_mov_b32 s44, 7168
    buffer_load_dwordx4 v[208:211], v207, s[64:67], s44 offen sc1
    s_mov_b32 s44, 15360
    buffer_load_dwordx4 v[212:215], v207, s[64:67], s44 offen sc1
    v_add_u32 v1, s40, v240
    s_waitcnt vmcnt(21)
    v_lshlrev_b32 v216, 16, v120
    v_and_b32 v217, 0xffff0000, v120
    v_lshlrev_b32 v218, 16, v121
    v_and_b32 v219, 0xffff0000, v121
    v_fma_f32 v216, v216, v136, v140
    v_fma_f32 v217, v217, v137, v141
    v_fma_f32 v218, v218, v138, v142
    v_fma_f32 v219, v219, v139, v143
    v_cvt_pk_bf16_f32 v120, v216, v217
    v_cvt_pk_bf16_f32 v121, v218, v219
    ds_write_b64 v1, v[120:121] offset:9728
    s_waitcnt vmcnt(18)
    v_lshlrev_b32 v220, 16, v122
    v_and_b32 v221, 0xffff0000, v122
    v_lshlrev_b32 v222, 16, v123
    v_and_b32 v223, 0xffff0000, v123
    v_fma_f32 v220, v220, v144, v148
    v_fma_f32 v221, v221, v145, v149
    v_fma_f32 v222, v222, v146, v150
    v_fma_f32 v223, v223, v147, v151
    v_cvt_pk_bf16_f32 v122, v220, v221
    v_cvt_pk_bf16_f32 v123, v222, v223
    ds_write_b64 v1, v[122:123] offset:10240
    s_waitcnt vmcnt(15)
    v_lshlrev_b32 v216, 16, v124
    v_and_b32 v217, 0xffff0000, v124
    v_lshlrev_b32 v218, 16, v125
    v_and_b32 v219, 0xffff0000, v125
    v_fma_f32 v216, v216, v152, v156
    v_fma_f32 v217, v217, v153, v157
    v_fma_f32 v218, v218, v154, v158
    v_fma_f32 v219, v219, v155, v159
    v_cvt_pk_bf16_f32 v124, v216, v217
    v_cvt_pk_bf16_f32 v125, v218, v219
    ds_write_b64 v1, v[124:125] offset:10752
    s_waitcnt vmcnt(12)
    v_lshlrev_b32 v220, 16, v126
    v_and_b32 v221, 0xffff0000, v126
    v_lshlrev_b32 v222, 16, v127
    v_and_b32 v223, 0xffff0000, v127
    v_fma_f32 v220, v220, v160, v164
    v_fma_f32 v221, v221, v161, v165
    v_fma_f32 v222, v222, v162, v166
    v_fma_f32 v223, v223, v163, v167
    v_cvt_pk_bf16_f32 v126, v220, v221
    v_cvt_pk_bf16_f32 v127, v222, v223
    ds_write_b64 v1, v[126:127] offset:11264
    s_waitcnt vmcnt(9)
    v_lshlrev_b32 v216, 16, v128
    v_and_b32 v217, 0xffff0000, v128
    v_lshlrev_b32 v218, 16, v129
    v_and_b32 v219, 0xffff0000, v129
    v_fma_f32 v216, v216, v168, v172
    v_fma_f32 v217, v217, v169, v173
    v_fma_f32 v218, v218, v170, v174
    v_fma_f32 v219, v219, v171, v175
    v_cvt_pk_bf16_f32 v128, v216, v217
    v_cvt_pk_bf16_f32 v129, v218, v219
    ds_write_b64 v1, v[128:129] offset:11776
    s_waitcnt vmcnt(6)
    v_lshlrev_b32 v220, 16, v130
    v_and_b32 v221, 0xffff0000, v130
    v_lshlrev_b32 v222, 16, v131
    v_and_b32 v223, 0xffff0000, v131
    v_fma_f32 v220, v220, v176, v180
    v_fma_f32 v221, v221, v177, v181
    v_fma_f32 v222, v222, v178, v182
    v_fma_f32 v223, v223, v179, v183
    v_cvt_pk_bf16_f32 v130, v220, v221
    v_cvt_pk_bf16_f32 v131, v222, v223
    ds_write_b64 v1, v[130:131] offset:12288
    s_waitcnt vmcnt(3)
    v_lshlrev_b32 v216, 16, v132
    v_and_b32 v217, 0xffff0000, v132
    v_lshlrev_b32 v218, 16, v133
    v_and_b32 v219, 0xffff0000, v133
    v_fma_f32 v216, v216, v184, v188
    v_fma_f32 v217, v217, v185, v189
    v_fma_f32 v218, v218, v186, v190
    v_fma_f32 v219, v219, v187, v191
    v_cvt_pk_bf16_f32 v132, v216, v217
    v_cvt_pk_bf16_f32 v133, v218, v219
    ds_write_b64 v1, v[132:133] offset:12800
    s_waitcnt vmcnt(0)
    v_lshlrev_b32 v220, 16, v134
    v_and_b32 v221, 0xffff0000, v134
    v_lshlrev_b32 v222, 16, v135
    v_and_b32 v223, 0xffff0000, v135
    v_fma_f32 v220, v220, v208, v212
    v_fma_f32 v221, v221, v209, v213
    v_fma_f32 v222, v222, v210, v214
    v_fma_f32 v223, v223, v211, v215
    v_cvt_pk_bf16_f32 v134, v220, v221
    v_cvt_pk_bf16_f32 v135, v222, v223
    ds_write_b64 v1, v[134:135] offset:13312
    v_mov_b32 v208, 0
    v_mov_b32 v209, 0
    v_mov_b32 v210, 0
    v_mov_b32 v211, 0
    v_mov_b32 v212, 0
    v_mov_b32 v213, 0
    v_mov_b32 v214, 0
    v_mov_b32 v215, 0
    v_mov_b32 v216, 0
    v_mov_b32 v217, 0
    v_mov_b32 v218, 0
    v_mov_b32 v219, 0
    v_mov_b32 v220, 0
    v_mov_b32 v221, 0
    v_mov_b32 v222, 0
    v_mov_b32 v223, 0
    v_mov_b32 v224, 0
    v_mov_b32 v225, 0
    v_mov_b32 v226, 0
    v_mov_b32 v227, 0
    v_mov_b32 v228, 0
    v_mov_b32 v229, 0
    v_mov_b32 v230, 0
    v_mov_b32 v231, 0
    v_mov_b32 v232, 0
    v_mov_b32 v233, 0
    v_mov_b32 v234, 0
    v_mov_b32 v235, 0
    v_mov_b32 v236, 0
    v_mov_b32 v237, 0
    v_mov_b32 v238, 0
    v_mov_b32 v239, 0
    s_lshl_b32 s44, s3, 2
    s_add_u32 s44, s44, 159760
    v_mov_b32 v1, s44
    s_mov_b32 s46, 0
L_gate_17:
    ds_read_b32 v2, v1
    s_add_u32 s46, s46, 1
    s_cmp_gt_u32 s46, 0x40000
    s_waitcnt lgkmcnt(0)
    s_cbranch_scc1 L_gateok_18
    v_cmp_le_u32 vcc, 4, v2
    s_cbranch_vccnz L_gateok_18
    s_sleep 2
    s_branch L_gate_17
L_gateok_18:
    s_waitcnt vmcnt(0) lgkmcnt(0)
    s_setprio 3
    ds_read2_b32 v[56:57], v24 offset0:144 offset1:145
    ds_read2_b32 v[58:59], v24 offset0:146 offset1:147
    ds_read_b128 v[88:91], v28 offset:64
    ds_read2_b32 v[60:61], v24 offset0:16 offset1:17
    ds_read2_b32 v[62:63], v24 offset0:18 offset1:19
    ds_read_b128 v[92:95], v28 offset:576
    ds_read2_b32 v[64:65], v25 offset0:144 offset1:145
    ds_read2_b32 v[66:67], v25 offset0:146 offset1:147
    ds_read_b128 v[96:99], v28 offset:1088
    ds_read2_b32 v[68:69], v25 offset0:16 offset1:17
    ds_read2_b32 v[70:71], v25 offset0:18 offset1:19
    ds_read_b128 v[100:103], v28 offset:1600
    ds_read2_b32 v[72:73], v26 offset0:144 offset1:145
    ds_read2_b32 v[74:75], v26 offset0:146 offset1:147
    ds_read_b128 v[104:107], v28 offset:2112
    ds_read2_b32 v[76:77], v26 offset0:16 offset1:17
    ds_read2_b32 v[78:79], v26 offset0:18 offset1:19
    ds_read_b128 v[108:111], v28 offset:2624
    ds_read2_b32 v[80:81], v27 offset0:144 offset1:145
    ds_read2_b32 v[82:83], v27 offset0:146 offset1:147
    ds_read_b128 v[112:115], v28 offset:3136
    ds_read2_b32 v[84:85], v27 offset0:16 offset1:17
    ds_read2_b32 v[86:87], v27 offset0:18 offset1:19
    ds_read_b128 v[116:119], v28 offset:3648
    s_mov_b32 s46, 0
L_conv_19:
    s_waitcnt lgkmcnt(14)
    v_mfma_f32_16x16x32_bf16 v[208:211], v[56:59], v[88:91], v[208:211]
    v_mfma_f32_16x16x32_bf16 v[212:215], v[56:59], v[92:95], v[212:215]
    ds_read2_b32 v[120:121], v24 offset0:128 offset1:129
    v_mfma_f32_16x16x32_bf16 v[212:215], v[60:63], v[88:91], v[212:215]
    ds_read2_b32 v[122:123], v24 offset0:130 offset1:131
    v_mfma_f32_16x16x32_bf16 v[216:219], v[60:63], v[92:95], v[216:219]
    v_mfma_f32_16x16x32_bf16 v[216:219], v[56:59], v[96:99], v[216:219]
    ds_read_b128 v[152:155], v28 offset:0
    v_mfma_f32_16x16x32_bf16 v[220:223], v[60:63], v[96:99], v[220:223]
    ds_read2_b32 v[124:125], v24 offset0:0 offset1:1
    v_mfma_f32_16x16x32_bf16 v[216:219], v[64:67], v[88:91], v[216:219]
    ds_read2_b32 v[126:127], v24 offset0:2 offset1:3
    v_mfma_f32_16x16x32_bf16 v[220:223], v[64:67], v[92:95], v[220:223]
    v_mfma_f32_16x16x32_bf16 v[224:227], v[64:67], v[96:99], v[224:227]
    ds_read_b128 v[156:159], v28 offset:512
    s_waitcnt lgkmcnt(14)
    v_mfma_f32_16x16x32_bf16 v[220:223], v[56:59], v[100:103], v[220:223]
    ds_read2_b32 v[128:129], v25 offset0:128 offset1:129
    v_mfma_f32_16x16x32_bf16 v[224:227], v[60:63], v[100:103], v[224:227]
    ds_read2_b32 v[130:131], v25 offset0:130 offset1:131
    v_mfma_f32_16x16x32_bf16 v[228:231], v[64:67], v[100:103], v[228:231]
    v_mfma_f32_16x16x32_bf16 v[220:223], v[68:71], v[88:91], v[220:223]
    ds_read_b128 v[160:163], v28 offset:1024
    v_mfma_f32_16x16x32_bf16 v[224:227], v[68:71], v[92:95], v[224:227]
    ds_read2_b32 v[132:133], v25 offset0:0 offset1:1
    v_mfma_f32_16x16x32_bf16 v[228:231], v[68:71], v[96:99], v[228:231]
    ds_read2_b32 v[134:135], v25 offset0:2 offset1:3
    v_mfma_f32_16x16x32_bf16 v[232:235], v[68:71], v[100:103], v[232:235]
    v_mfma_f32_16x16x32_bf16 v[224:227], v[56:59], v[104:107], v[224:227]
    ds_read_b128 v[164:167], v28 offset:1536
    v_mfma_f32_16x16x32_bf16 v[228:231], v[60:63], v[104:107], v[228:231]
    ds_read2_b32 v[136:137], v26 offset0:128 offset1:129
    v_mfma_f32_16x16x32_bf16 v[232:235], v[64:67], v[104:107], v[232:235]
    ds_read2_b32 v[138:139], v26 offset0:130 offset1:131
    v_mfma_f32_16x16x32_bf16 v[236:239], v[68:71], v[104:107], v[236:239]
    v_mfma_f32_16x16x32_bf16 v[224:227], v[72:75], v[88:91], v[224:227]
    ds_read_b128 v[168:171], v28 offset:2048
    v_mfma_f32_16x16x32_bf16 v[228:231], v[72:75], v[92:95], v[228:231]
    ds_read2_b32 v[140:141], v26 offset0:0 offset1:1
    v_mfma_f32_16x16x32_bf16 v[232:235], v[72:75], v[96:99], v[232:235]
    ds_read2_b32 v[142:143], v26 offset0:2 offset1:3
    v_mfma_f32_16x16x32_bf16 v[236:239], v[72:75], v[100:103], v[236:239]
    s_waitcnt lgkmcnt(14)
    v_mfma_f32_16x16x32_bf16 v[228:231], v[56:59], v[108:111], v[228:231]
    ds_read_b128 v[172:175], v28 offset:2560
    v_mfma_f32_16x16x32_bf16 v[232:235], v[60:63], v[108:111], v[232:235]
    ds_read2_b32 v[144:145], v27 offset0:128 offset1:129
    v_mfma_f32_16x16x32_bf16 v[236:239], v[64:67], v[108:111], v[236:239]
    ds_read2_b32 v[146:147], v27 offset0:130 offset1:131
    v_mfma_f32_16x16x32_bf16 v[228:231], v[76:79], v[88:91], v[228:231]
    v_mfma_f32_16x16x32_bf16 v[232:235], v[76:79], v[92:95], v[232:235]
    ds_read_b128 v[176:179], v28 offset:3072
    v_mfma_f32_16x16x32_bf16 v[236:239], v[76:79], v[96:99], v[236:239]
    ds_read2_b32 v[148:149], v27 offset0:0 offset1:1
    v_mfma_f32_16x16x32_bf16 v[232:235], v[56:59], v[112:115], v[232:235]
    ds_read2_b32 v[150:151], v27 offset0:2 offset1:3
    v_mfma_f32_16x16x32_bf16 v[236:239], v[60:63], v[112:115], v[236:239]
    v_mfma_f32_16x16x32_bf16 v[232:235], v[80:83], v[88:91], v[232:235]
    ds_read_b128 v[180:183], v28 offset:3584
    v_mfma_f32_16x16x32_bf16 v[236:239], v[80:83], v[92:95], v[236:239]
    v_mfma_f32_16x16x32_bf16 v[236:239], v[56:59], v[116:119], v[236:239]
    v_mfma_f32_16x16x32_bf16 v[236:239], v[84:87], v[88:91], v[236:239]
    v_mfma_f32_16x16x32_bf16 v[208:211], v[120:123], v[152:155], v[208:211]
    v_subrev_u32 v24, 128, v24
    v_subrev_u32 v25, 128, v25
    v_subrev_u32 v26, 128, v26
    v_subrev_u32 v27, 128, v27
    v_subrev_u32 v28, 128, v28
    s_waitcnt lgkmcnt(14)
    v_mfma_f32_16x16x32_bf16 v[212:215], v[120:123], v[156:159], v[212:215]
    ds_read2_b32 v[56:57], v24 offset0:144 offset1:145
    v_mfma_f32_16x16x32_bf16 v[212:215], v[124:127], v[152:155], v[212:215]
    ds_read2_b32 v[58:59], v24 offset0:146 offset1:147
    v_mfma_f32_16x16x32_bf16 v[216:219], v[124:127], v[156:159], v[216:219]
    v_mfma_f32_16x16x32_bf16 v[216:219], v[120:123], v[160:163], v[216:219]
    ds_read_b128 v[88:91], v28 offset:64
    v_mfma_f32_16x16x32_bf16 v[220:223], v[124:127], v[160:163], v[220:223]
    ds_read2_b32 v[60:61], v24 offset0:16 offset1:17
    v_mfma_f32_16x16x32_bf16 v[216:219], v[128:131], v[152:155], v[216:219]
    ds_read2_b32 v[62:63], v24 offset0:18 offset1:19
    v_mfma_f32_16x16x32_bf16 v[220:223], v[128:131], v[156:159], v[220:223]
    v_mfma_f32_16x16x32_bf16 v[224:227], v[128:131], v[160:163], v[224:227]
    ds_read_b128 v[92:95], v28 offset:576
    s_waitcnt lgkmcnt(14)
    v_mfma_f32_16x16x32_bf16 v[220:223], v[120:123], v[164:167], v[220:223]
    ds_read2_b32 v[64:65], v25 offset0:144 offset1:145
    v_mfma_f32_16x16x32_bf16 v[224:227], v[124:127], v[164:167], v[224:227]
    ds_read2_b32 v[66:67], v25 offset0:146 offset1:147
    v_mfma_f32_16x16x32_bf16 v[228:231], v[128:131], v[164:167], v[228:231]
    v_mfma_f32_16x16x32_bf16 v[220:223], v[132:135], v[152:155], v[220:223]
    ds_read_b128 v[96:99], v28 offset:1088
    v_mfma_f32_16x16x32_bf16 v[224:227], v[132:135], v[156:159], v[224:227]
    ds_read2_b32 v[68:69], v25 offset0:16 offset1:17
    v_mfma_f32_16x16x32_bf16 v[228:231], v[132:135], v[160:163], v[228:231]
    ds_read2_b32 v[70:71], v25 offset0:18 offset1:19
    v_mfma_f32_16x16x32_bf16 v[232:235], v[132:135], v[164:167], v[232:235]
    v_mfma_f32_16x16x32_bf16 v[224:227], v[120:123], v[168:171], v[224:227]
    ds_read_b128 v[100:103], v28 offset:1600
    v_mfma_f32_16x16x32_bf16 v[228:231], v[124:127], v[168:171], v[228:231]
    ds_read2_b32 v[72:73], v26 offset0:144 offset1:145
    v_mfma_f32_16x16x32_bf16 v[232:235], v[128:131], v[168:171], v[232:235]
    ds_read2_b32 v[74:75], v26 offset0:146 offset1:147
    v_mfma_f32_16x16x32_bf16 v[236:239], v[132:135], v[168:171], v[236:239]
    v_mfma_f32_16x16x32_bf16 v[224:227], v[136:139], v[152:155], v[224:227]
    ds_read_b128 v[104:107], v28 offset:2112
    v_mfma_f32_16x16x32_bf16 v[228:231], v[136:139], v[156:159], v[228:231]
    ds_read2_b32 v[76:77], v26 offset0:16 offset1:17
    v_mfma_f32_16x16x32_bf16 v[232:235], v[136:139], v[160:163], v[232:235]
    ds_read2_b32 v[78:79], v26 offset0:18 offset1:19
    v_mfma_f32_16x16x32_bf16 v[236:239], v[136:139], v[164:167], v[236:239]
    s_waitcnt lgkmcnt(14)
    v_mfma_f32_16x16x32_bf16 v[228:231], v[120:123], v[172:175], v[228:231]
    ds_read_b128 v[108:111], v28 offset:2624
    v_mfma_f32_16x16x32_bf16 v[232:235], v[124:127], v[172:175], v[232:235]
    ds_read2_b32 v[80:81], v27 offset0:144 offset1:145
    v_mfma_f32_16x16x32_bf16 v[236:239], v[128:131], v[172:175], v[236:239]
    ds_read2_b32 v[82:83], v27 offset0:146 offset1:147
    v_mfma_f32_16x16x32_bf16 v[228:231], v[140:143], v[152:155], v[228:231]
    v_mfma_f32_16x16x32_bf16 v[232:235], v[140:143], v[156:159], v[232:235]
    ds_read_b128 v[112:115], v28 offset:3136
    v_mfma_f32_16x16x32_bf16 v[236:239], v[140:143], v[160:163], v[236:239]
    ds_read2_b32 v[84:85], v27 offset0:16 offset1:17
    v_mfma_f32_16x16x32_bf16 v[232:235], v[120:123], v[176:179], v[232:235]
    ds_read2_b32 v[86:87], v27 offset0:18 offset1:19
    v_mfma_f32_16x16x32_bf16 v[236:239], v[124:127], v[176:179], v[236:239]
    v_mfma_f32_16x16x32_bf16 v[232:235], v[144:147], v[152:155], v[232:235]
    ds_read_b128 v[116:119], v28 offset:3648
    v_mfma_f32_16x16x32_bf16 v[236:239], v[144:147], v[156:159], v[236:239]
    v_mfma_f32_16x16x32_bf16 v[236:239], v[120:123], v[180:183], v[236:239]
    v_mfma_f32_16x16x32_bf16 v[236:239], v[148:151], v[152:155], v[236:239]
    s_add_u32 s46, s46, 1
    s_cmp_lt_u32 s46, 4
    s_cbranch_scc1 L_conv_19
    v_and_b32 v1, 15, v0
    v_lshrrev_b32 v2, 4, v0
    v_lshlrev_b32 v1, 5, v1
    v_lshl_add_u32 v1, v2, 3, v1
    v_add_u32 v1, s40, v1
    v_add_u32 v2, s40, v207
    s_nop 1
    v_cvt_pk_bf16_f32 v184, v208, v209
    v_cvt_pk_bf16_f32 v185, v210, v211
    ds_write_b64 v1, v[184:185] offset:0
    v_cvt_pk_bf16_f32 v186, v212, v213
    v_cvt_pk_bf16_f32 v187, v214, v215
    ds_write_b64 v1, v[186:187] offset:512
    v_cvt_pk_bf16_f32 v188, v216, v217
    v_cvt_pk_bf16_f32 v189, v218, v219
    ds_write_b64 v1, v[188:189] offset:1024
    v_cvt_pk_bf16_f32 v190, v220, v221
    v_cvt_pk_bf16_f32 v191, v222, v223
    ds_write_b64 v1, v[190:191] offset:1536
    v_cvt_pk_bf16_f32 v192, v224, v225
    v_cvt_pk_bf16_f32 v193, v226, v227
    ds_write_b64 v1, v[192:193] offset:2048
    v_cvt_pk_bf16_f32 v194, v228, v229
    v_cvt_pk_bf16_f32 v195, v230, v231
    ds_write_b64 v1, v[194:195] offset:2560
    v_cvt_pk_bf16_f32 v196, v232, v233
    v_cvt_pk_bf16_f32 v197, v234, v235
    ds_write_b64 v1, v[196:197] offset:3072
    v_cvt_pk_bf16_f32 v198, v236, v237
    v_cvt_pk_bf16_f32 v199, v238, v239
    ds_write_b64 v1, v[198:199] offset:3584
    ds_read_b128 v[208:211], v2 offset:0
    ds_read_b128 v[212:215], v2 offset:1024
    ds_read_b128 v[216:219], v2 offset:2048
    ds_read_b128 v[220:223], v2 offset:3072
    s_waitcnt lgkmcnt(3)
    buffer_store_dwordx4 v[208:211], v207, s[60:63], s45 offen offset:0 sc1
    s_waitcnt lgkmcnt(2)
    buffer_store_dwordx4 v[212:215], v207, s[60:63], s45 offen offset:1024 sc1
    s_waitcnt lgkmcnt(1)
    buffer_store_dwordx4 v[216:219], v207, s[60:63], s45 offen offset:2048 sc1
    s_waitcnt lgkmcnt(0)
    buffer_store_dwordx4 v[220:223], v207, s[60:63], s45 offen offset:3072 sc1
    s_waitcnt vmcnt(0) lgkmcnt(0)
    s_mov_b64 exec, 1
    buffer_store_dwordx2 v[242:243], v205, s[52:55], s47 offen offset:0 sc1
    s_mov_b64 exec, -1
    s_endpgm
L_loader:
    s_setprio 0
    s_bfe_u32 s40, s2, 0x20001
    s_lshl_b32 s40, s40, 2
    s_lshr_b32 s44, s2, 6
    s_add_u32 s40, s40, s44
    s_and_b32 s41, s2, 1
    s_lshl_b32 s41, s41, 3
    s_bfe_u32 s44, s2, 0x30003
    s_add_u32 s41, s41, s44
    v_add_u32 v3, 0, v0
    v_mul_u32_u24 v24, 5462, v3
    v_lshrrev_b32 v24, 16, v24
    v_mul_u32_u24 v24, 2880, v24
    v_lshl_add_u32 v24, v0, 4, v24
    v_add_u32 v3, 64, v0
    v_mul_u32_u24 v25, 5462, v3
    v_lshrrev_b32 v25, 16, v25
    v_mul_u32_u24 v25, 2880, v25
    v_lshl_add_u32 v25, v0, 4, v25
    v_add_u32 v3, 128, v0
    v_mul_u32_u24 v26, 5462, v3
    v_lshrrev_b32 v26, 16, v26
    v_mul_u32_u24 v26, 2880, v26
    v_lshl_add_u32 v26, v0, 4, v26
    s_mul_i32 s47, s41, 192
    s_and_b32 s44, s40, 3
    s_mul_i32 s44, s44, 3
    s_add_u32 s44, s44, s41
    s_sub_u32 s45, s44, 10
    s_cmp_ge_u32 s44, 10
    s_cselect_b32 s44, s45, s44
    s_sub_u32 s45, s44, 10
    s_cmp_ge_u32 s44, 10
    s_cselect_b32 s44, s45, s44
    s_mul_i32 s101, s44, 196608
    s_add_u32 s44, s44, 10
    s_sub_u32 s45, s44, 10
    s_cmp_ge_u32 s44, 10
    s_cselect_b32 s44, s45, s44
    s_lshl_b32 s100, s44, 7
    s_waitcnt lgkmcnt(0)
    s_mov_b32 s64, s28
    s_and_b32 s65, s29, 0xffff
    s_mov_b32 s66, 0x1e0000
    s_mov_b32 s67, 0x00020000
    s_mov_b32 m0, 0
    s_add_u32 s44, s47, s101
    buffer_load_dwordx4 v24, s[64:67], s44 offen offset:0 lds
    s_add_u32 s101, s101, 196608
    s_cmp_ge_u32 s101, 1966080
    s_cselect_b32 s101, 0, s101
    buffer_load_dwordx4 v25, s[64:67], s44 offen offset:1024 lds
    buffer_load_dwordx4 v26, s[64:67], s44 offen offset:2048 lds
    s_mov_b32 m0, 3072
    s_add_u32 s44, s44, 49152
    buffer_load_dwordx4 v24, s[64:67], s44 offen offset:0 lds
    buffer_load_dwordx4 v25, s[64:67], s44 offen offset:1024 lds
    buffer_load_dwordx4 v26, s[64:67], s44 offen offset:2048 lds
    s_mov_b32 m0, 6144
    s_add_u32 s44, s44, 49152
    buffer_load_dwordx4 v24, s[64:67], s44 offen offset:0 lds
    buffer_load_dwordx4 v25, s[64:67], s44 offen offset:1024 lds
    buffer_load_dwordx4 v26, s[64:67], s44 offen offset:2048 lds
    s_mov_b32 m0, 9216
    s_add_u32 s44, s44, 49152
    buffer_load_dwordx4 v24, s[64:67], s44 offen offset:0 lds
    buffer_load_dwordx4 v25, s[64:67], s44 offen offset:1024 lds
    buffer_load_dwordx4 v26, s[64:67], s44 offen offset:2048 lds
    s_mul_i32 s44, s2, 13108
    s_lshr_b32 s44, s44, 16
    s_mul_i32 s45, s44, 5
    s_sub_u32 s45, s2, s45
    s_mul_i32 s48, s44, 40960
    s_lshl_b32 s45, s45, 8
    s_add_u32 s48, s48, s45
    v_lshrrev_b32 v1, 4, v0
    v_and_b32 v2, 15, v0
    v_mul_u32_u24 v36, 1280, v1
    v_lshl_add_u32 v36, v2, 4, v36
    v_add_u32 v37, 4096, v36
    v_add_u32 v38, 8192, v36
    v_add_u32 v39, 12288, v36
    v_lshrrev_b32 v1, 4, v0
    v_lshrrev_b32 v2, 3, v0
    v_and_b32 v3, 7, v0
    v_xor_b32 v3, v3, v1
    v_mul_u32_u24 v20, 1280, v2
    v_lshl_add_u32 v20, v3, 4, v20
    v_xor_b32 v21, 64, v20
    v_add_u32 v22, 18432, v20
    v_add_u32 v23, 27648, v21
    v_add_u32 v21, 9216, v21
    s_mul_i32 s46, s40, 163840
    s_mov_b32 s68, s32
    s_and_b32 s69, s33, 0xffff
    s_mov_b32 s70, 0x1e0000
    s_mov_b32 s71, 0x00020000
    s_mov_b32 s60, s8
    s_and_b32 s61, s9, 0xffff
    s_mov_b32 s62, 0x280000
    s_mov_b32 s63, 0x00020000
    v_lshlrev_b32 v64, 2, v0
    v_add_u32 v64, 159808, v64
    v_mov_b32 v1, 159744
    v_cmp_eq_u32 vcc, 0, v0
    v_mov_b32 v66, 159760
    s_mov_b32 s50, 0
    v_cndmask_b32 v64, v64, v1, vcc
    s_mov_b32 m0, 36864
    s_nop 0
    buffer_load_dwordx4 v36, s[68:71], s48 offen offset:0 lds
    buffer_load_dwordx4 v37, s[68:71], s48 offen offset:1024 lds
    buffer_load_dwordx4 v38, s[68:71], s48 offen offset:2048 lds
    buffer_load_dwordx4 v39, s[68:71], s48 offen offset:3072 lds
    s_mov_b32 m0, 40960
    s_add_u32 s48, s48, 20480
    buffer_load_dwordx4 v36, s[68:71], s48 offen offset:0 lds
    buffer_load_dwordx4 v37, s[68:71], s48 offen offset:1024 lds
    buffer_load_dwordx4 v38, s[68:71], s48 offen offset:2048 lds
    buffer_load_dwordx4 v39, s[68:71], s48 offen offset:3072 lds
    s_mov_b32 m0, 12288
    s_add_u32 s44, s47, s101
    buffer_load_dwordx4 v24, s[64:67], s44 offen offset:0 lds
    s_add_u32 s101, s101, 196608
    s_cmp_ge_u32 s101, 1966080
    s_cselect_b32 s101, 0, s101
    buffer_load_dwordx4 v25, s[64:67], s44 offen offset:1024 lds
    buffer_load_dwordx4 v26, s[64:67], s44 offen offset:2048 lds
    s_mov_b32 m0, 15360
    s_add_u32 s44, s44, 49152
    buffer_load_dwordx4 v24, s[64:67], s44 offen offset:0 lds
    s_waitcnt vmcnt(12)
    s_max_u32 s50, s50, 1
    v_mov_b32 v65, s50
    ds_write_b32 v64, v65
    buffer_load_dwordx4 v25, s[64:67], s44 offen offset:1024 lds
    buffer_load_dwordx4 v26, s[64:67], s44 offen offset:2048 lds
    s_mov_b32 m0, 18432
    s_add_u32 s44, s44, 49152
    buffer_load_dwordx4 v24, s[64:67], s44 offen offset:0 lds
    buffer_load_dwordx4 v25, s[64:67], s44 offen offset:1024 lds
    buffer_load_dwordx4 v26, s[64:67], s44 offen offset:2048 lds
    s_mov_b32 m0, 21504
    s_add_u32 s44, s44, 49152
    buffer_load_dwordx4 v24, s[64:67], s44 offen offset:0 lds
    buffer_load_dwordx4 v25, s[64:67], s44 offen offset:1024 lds
    buffer_load_dwordx4 v26, s[64:67], s44 offen offset:2048 lds
    s_waitcnt vmcnt(12)
    s_max_u32 s50, s50, 2
    v_mov_b32 v65, s50
    ds_write_b32 v64, v65
    s_setprio 0
    s_mov_b32 m0, 24576
    s_add_u32 s44, s47, s101
    buffer_load_dwordx4 v24, s[64:67], s44 offen offset:0 lds
    ds_read_b128 v[60:63], v66
    s_add_u32 s101, s101, 196608
    s_cmp_ge_u32 s101, 1966080
    s_cselect_b32 s101, 0, s101
    buffer_load_dwordx4 v25, s[64:67], s44 offen offset:1024 lds
    buffer_load_dwordx4 v26, s[64:67], s44 offen offset:2048 lds
    s_mov_b32 m0, 27648
    s_add_u32 s44, s44, 49152
    buffer_load_dwordx4 v24, s[64:67], s44 offen offset:0 lds
    buffer_load_dwordx4 v25, s[64:67], s44 offen offset:1024 lds
    buffer_load_dwordx4 v26, s[64:67], s44 offen offset:2048 lds
    s_mov_b32 m0, 30720
    s_add_u32 s44, s44, 49152
    buffer_load_dwordx4 v24, s[64:67], s44 offen offset:0 lds
    buffer_load_dwordx4 v25, s[64:67], s44 offen offset:1024 lds
    buffer_load_dwordx4 v26, s[64:67], s44 offen offset:2048 lds
    s_mov_b32 m0, 33792
    s_add_u32 s44, s44, 49152
    buffer_load_dwordx4 v24, s[64:67], s44 offen offset:0 lds
    buffer_load_dwordx4 v25, s[64:67], s44 offen offset:1024 lds
    buffer_load_dwordx4 v26, s[64:67], s44 offen offset:2048 lds
    s_waitcnt vmcnt(12)
    s_max_u32 s50, s50, 3
    v_mov_b32 v65, s50
    ds_write_b32 v64, v65
    s_bfe_u32 s42, s2, 0x20001
    s_lshl_b32 s42, s42, 3
    s_lshr_b32 s44, s2, 5
    s_add_u32 s42, s42, s44
    s_and_b32 s43, s2, 1
    s_lshl_b32 s43, s43, 2
    s_bfe_u32 s44, s2, 0x20003
    s_add_u32 s43, s43, s44
    s_add_u32 s72, s38, 0x600000
    s_addc_u32 s73, s39, 0
    s_and_b32 s73, s73, 0xffff
    s_mov_b32 s74, 0x1e0000
    s_mov_b32 s75, 0x00020000
    s_add_u32 s4, s38, 0x7ec000
    s_addc_u32 s5, s39, 0
    s_and_b32 s5, s5, 0xffff
    s_mov_b32 s6, 0xb000
    s_mov_b32 s7, 0x00020000
    v_lshlrev_b32 v7, 4, v0
    v_mov_b32 v6, 0
    v_add_u32 v40, 0, v7
    v_add_u32 v41, 11264, v7
    v_add_u32 v42, 22528, v7
    v_add_u32 v43, 33792, v7
    s_mul_i32 s53, s43, 245760
    v_min_u32 v67, 240, v7
    s_waitcnt lgkmcnt(1)
    v_min3_u32 v60, v60, v61, v62
    v_min_u32 v60, v60, v63
    s_mov_b32 s51, 2
    v_readfirstlane_b32 s49, v60
    s_mov_b32 s52, 4
    s_cmp_ge_u32 s49, 2
    s_cbranch_scc1 L_relok_20
    s_call_b64 s[58:59], L_ld_slow
L_relok_20:
    s_mov_b32 m0, 36864
    s_add_u32 s44, s47, s101
    buffer_load_dwordx4 v24, s[64:67], s44 offen offset:0 lds
    ds_read_b128 v[60:63], v66
    s_add_u32 s101, s101, 196608
    s_cmp_ge_u32 s101, 1966080
    s_cselect_b32 s101, 0, s101
    buffer_load_dwordx4 v25, s[64:67], s44 offen offset:1024 lds
    buffer_load_dwordx4 v26, s[64:67], s44 offen offset:2048 lds
    s_mov_b32 m0, 39936
    s_add_u32 s44, s44, 49152
    buffer_load_dwordx4 v24, s[64:67], s44 offen offset:0 lds
    buffer_load_dwordx4 v25, s[64:67], s44 offen offset:1024 lds
    buffer_load_dwordx4 v26, s[64:67], s44 offen offset:2048 lds
    s_mov_b32 m0, 43008
    s_add_u32 s44, s44, 49152
    buffer_load_dwordx4 v24, s[64:67], s44 offen offset:0 lds
    buffer_load_dwordx4 v25, s[64:67], s44 offen offset:1024 lds
    buffer_load_dwordx4 v26, s[64:67], s44 offen offset:2048 lds
    s_mov_b32 m0, 46080
    s_add_u32 s44, s44, 49152
    buffer_load_dwordx4 v24, s[64:67], s44 offen offset:0 lds
    buffer_load_dwordx4 v25, s[64:67], s44 offen offset:1024 lds
    buffer_load_dwordx4 v26, s[64:67], s44 offen offset:2048 lds
    s_waitcnt vmcnt(12)
    s_max_u32 s50, s50, 4
    v_mov_b32 v65, s50
    ds_write_b32 v64, v65
    s_waitcnt lgkmcnt(1)
    v_min3_u32 v60, v60, v61, v62
    v_min_u32 v60, v60, v63
    s_mov_b32 s51, 4
    v_readfirstlane_b32 s49, v60
    s_mov_b32 s52, 5
    s_cmp_ge_u32 s49, 4
    s_cbranch_scc1 L_relok_21
    s_call_b64 s[58:59], L_ld_slow
L_relok_21:
    s_mov_b32 m0, 0
    s_add_u32 s44, s47, s101
    buffer_load_dwordx4 v24, s[64:67], s44 offen offset:0 lds
    ds_read_b128 v[60:63], v66
    s_add_u32 s101, s101, 196608
    s_cmp_ge_u32 s101, 1966080
    s_cselect_b32 s101, 0, s101
    buffer_load_dwordx4 v25, s[64:67], s44 offen offset:1024 lds
    buffer_load_dwordx4 v26, s[64:67], s44 offen offset:2048 lds
    s_mov_b32 m0, 3072
    s_add_u32 s44, s44, 49152
    buffer_load_dwordx4 v24, s[64:67], s44 offen offset:0 lds
    buffer_load_dwordx4 v25, s[64:67], s44 offen offset:1024 lds
    buffer_load_dwordx4 v26, s[64:67], s44 offen offset:2048 lds
    s_mov_b32 m0, 6144
    s_add_u32 s44, s44, 49152
    buffer_load_dwordx4 v24, s[64:67], s44 offen offset:0 lds
    buffer_load_dwordx4 v25, s[64:67], s44 offen offset:1024 lds
    buffer_load_dwordx4 v26, s[64:67], s44 offen offset:2048 lds
    s_mov_b32 m0, 9216
    s_add_u32 s44, s44, 49152
    buffer_load_dwordx4 v24, s[64:67], s44 offen offset:0 lds
    buffer_load_dwordx4 v25, s[64:67], s44 offen offset:1024 lds
    buffer_load_dwordx4 v26, s[64:67], s44 offen offset:2048 lds
    s_waitcnt vmcnt(12)
    s_max_u32 s50, s50, 5
    v_mov_b32 v65, s50
    ds_write_b32 v64, v65
    s_waitcnt lgkmcnt(1)
    v_min3_u32 v60, v60, v61, v62
    v_min_u32 v60, v60, v63
    s_mov_b32 s51, 6
    v_readfirstlane_b32 s49, v60
    s_mov_b32 s52, 6
    s_cmp_ge_u32 s49, 6
    s_cbranch_scc1 L_relok_22
    s_call_b64 s[58:59], L_ld_slow
L_relok_22:
    s_mov_b32 m0, 12288
    s_add_u32 s44, s47, s101
    buffer_load_dwordx4 v24, s[64:67], s44 offen offset:0 lds
    ds_read_b128 v[60:63], v66
    s_add_u32 s101, s101, 196608
    s_cmp_ge_u32 s101, 1966080
    s_cselect_b32 s101, 0, s101
    buffer_load_dwordx4 v25, s[64:67], s44 offen offset:1024 lds
    buffer_load_dwordx4 v26, s[64:67], s44 offen offset:2048 lds
    s_mov_b32 m0, 15360
    s_add_u32 s44, s44, 49152
    buffer_load_dwordx4 v24, s[64:67], s44 offen offset:0 lds
    buffer_load_dwordx4 v25, s[64:67], s44 offen offset:1024 lds
    buffer_load_dwordx4 v26, s[64:67], s44 offen offset:2048 lds
    s_mov_b32 m0, 18432
    s_add_u32 s44, s44, 49152
    buffer_load_dwordx4 v24, s[64:67], s44 offen offset:0 lds
    buffer_load_dwordx4 v25, s[64:67], s44 offen offset:1024 lds
    buffer_load_dwordx4 v26, s[64:67], s44 offen offset:2048 lds
    s_mov_b32 m0, 21504
    s_add_u32 s44, s44, 49152
    buffer_load_dwordx4 v24, s[64:67], s44 offen offset:0 lds
    buffer_load_dwordx4 v25, s[64:67], s44 offen offset:1024 lds
    buffer_load_dwordx4 v26, s[64:67], s44 offen offset:2048 lds
    s_waitcnt vmcnt(12)
    s_max_u32 s50, s50, 6
    v_mov_b32 v65, s50
    ds_write_b32 v64, v65
    s_waitcnt lgkmcnt(1)
    v_min3_u32 v60, v60, v61, v62
    v_min_u32 v60, v60, v63
    s_mov_b32 s51, 8
    v_readfirstlane_b32 s49, v60
    s_mov_b32 s52, 7
    s_cmp_ge_u32 s49, 8
    s_cbranch_scc1 L_relok_23
    s_call_b64 s[58:59], L_ld_slow
L_relok_23:
    s_mov_b32 m0, 24576
    s_add_u32 s44, s47, s101
    buffer_load_dwordx4 v24, s[64:67], s44 offen offset:0 lds
    ds_read_b128 v[60:63], v66
    s_add_u32 s101, s101, 196608
    s_cmp_ge_u32 s101, 1966080
    s_cselect_b32 s101, 0, s101
    buffer_load_dwordx4 v25, s[64:67], s44 offen offset:1024 lds
    buffer_load_dwordx4 v26, s[64:67], s44 offen offset:2048 lds
    s_mov_b32 m0, 27648
    s_add_u32 s44, s44, 49152
    buffer_load_dwordx4 v24, s[64:67], s44 offen offset:0 lds
    buffer_load_dwordx4 v25, s[64:67], s44 offen offset:1024 lds
    buffer_load_dwordx4 v26, s[64:67], s44 offen offset:2048 lds
    s_mov_b32 m0, 30720
    s_add_u32 s44, s44, 49152
    buffer_load_dwordx4 v24, s[64:67], s44 offen offset:0 lds
    buffer_load_dwordx4 v25, s[64:67], s44 offen offset:1024 lds
    buffer_load_dwordx4 v26, s[64:67], s44 offen offset:2048 lds
    s_mov_b32 m0, 33792
    s_add_u32 s44, s44, 49152
    buffer_load_dwordx4 v24, s[64:67], s44 offen offset:0 lds
    buffer_load_dwordx4 v25, s[64:67], s44 offen offset:1024 lds
    buffer_load_dwordx4 v26, s[64:67], s44 offen offset:2048 lds
    s_waitcnt vmcnt(12)
    s_max_u32 s50, s50, 7
    v_mov_b32 v65, s50
    ds_write_b32 v64, v65
    s_waitcnt lgkmcnt(1)
    v_min3_u32 v60, v60, v61, v62
    v_min_u32 v60, v60, v63
    s_mov_b32 s51, 10
    v_readfirstlane_b32 s49, v60
    s_mov_b32 s52, 8
    s_cmp_ge_u32 s49, 10
    s_cbranch_scc1 L_relok_24
    s_call_b64 s[58:59], L_ld_slow
L_relok_24:
    s_mov_b32 m0, 36864
    s_add_u32 s44, s47, s101
    buffer_load_dwordx4 v24, s[64:67], s44 offen offset:0 lds
    ds_read_b128 v[60:63], v66
    s_add_u32 s101, s101, 196608
    s_cmp_ge_u32 s101, 1966080
    s_cselect_b32 s101, 0, s101
    buffer_load_dwordx4 v25, s[64:67], s44 offen offset:1024 lds
    buffer_load_dwordx4 v26, s[64:67], s44 offen offset:2048 lds
    s_mov_b32 m0, 39936
    s_add_u32 s44, s44, 49152
    buffer_load_dwordx4 v24, s[64:67], s44 offen offset:0 lds
    buffer_load_dwordx4 v25, s[64:67], s44 offen offset:1024 lds
    buffer_load_dwordx4 v26, s[64:67], s44 offen offset:2048 lds
    s_mov_b32 m0, 43008
    s_add_u32 s44, s44, 49152
    buffer_load_dwordx4 v24, s[64:67], s44 offen offset:0 lds
    buffer_load_dwordx4 v25, s[64:67], s44 offen offset:1024 lds
    buffer_load_dwordx4 v26, s[64:67], s44 offen offset:2048 lds
    s_mov_b32 m0, 46080
    s_add_u32 s44, s44, 49152
    buffer_load_dwordx4 v24, s[64:67], s44 offen offset:0 lds
    buffer_load_dwordx4 v25, s[64:67], s44 offen offset:1024 lds
    buffer_load_dwordx4 v26, s[64:67], s44 offen offset:2048 lds
    s_waitcnt vmcnt(12)
    s_max_u32 s50, s50, 8
    v_mov_b32 v65, s50
    ds_write_b32 v64, v65
    s_waitcnt lgkmcnt(1)
    v_min3_u32 v60, v60, v61, v62
    v_min_u32 v60, v60, v63
    s_mov_b32 s51, 12
    v_readfirstlane_b32 s49, v60
    s_mov_b32 s52, 9
    s_cmp_ge_u32 s49, 12
    s_cbranch_scc1 L_relok_25
    s_call_b64 s[58:59], L_ld_slow
L_relok_25:
    s_mov_b32 m0, 0
    s_add_u32 s44, s47, s101
    buffer_load_dwordx4 v24, s[64:67], s44 offen offset:0 lds
    ds_read_b128 v[60:63], v66
    s_add_u32 s101, s101, 196608
    s_cmp_ge_u32 s101, 1966080
    s_cselect_b32 s101, 0, s101
    buffer_load_dwordx4 v25, s[64:67], s44 offen offset:1024 lds
    buffer_load_dwordx4 v26, s[64:67], s44 offen offset:2048 lds
    s_mov_b32 m0, 3072
    s_add_u32 s44, s44, 49152
    buffer_load_dwordx4 v24, s[64:67], s44 offen offset:0 lds
    buffer_load_dwordx4 v25, s[64:67], s44 offen offset:1024 lds
    buffer_load_dwordx4 v26, s[64:67], s44 offen offset:2048 lds
    s_mov_b32 m0, 6144
    s_add_u32 s44, s44, 49152
    buffer_load_dwordx4 v24, s[64:67], s44 offen offset:0 lds
    buffer_load_dwordx4 v25, s[64:67], s44 offen offset:1024 lds
    buffer_load_dwordx4 v26, s[64:67], s44 offen offset:2048 lds
    s_mov_b32 m0, 9216
    s_add_u32 s44, s44, 49152
    buffer_load_dwordx4 v24, s[64:67], s44 offen offset:0 lds
    buffer_load_dwordx4 v25, s[64:67], s44 offen offset:1024 lds
    buffer_load_dwordx4 v26, s[64:67], s44 offen offset:2048 lds
    s_waitcnt vmcnt(12)
    s_max_u32 s50, s50, 9
    v_mov_b32 v65, s50
    ds_write_b32 v64, v65
    s_waitcnt lgkmcnt(1)
    v_min3_u32 v60, v60, v61, v62
    v_min_u32 v60, v60, v63
    s_mov_b32 s51, 14
    v_readfirstlane_b32 s49, v60
    s_mov_b32 s52, 10
    s_cmp_ge_u32 s49, 14
    s_cbranch_scc1 L_relok_26
    s_call_b64 s[58:59], L_ld_slow
L_relok_26:
    s_mov_b32 m0, 12288
    s_add_u32 s44, s47, s101
    buffer_load_dwordx4 v24, s[64:67], s44 offen offset:0 lds
    ds_read_b128 v[60:63], v66
    s_add_u32 s101, s101, 196608
    s_cmp_ge_u32 s101, 1966080
    s_cselect_b32 s101, 0, s101
    buffer_load_dwordx4 v25, s[64:67], s44 offen offset:1024 lds
    buffer_load_dwordx4 v26, s[64:67], s44 offen offset:2048 lds
    s_mov_b32 m0, 15360
    s_add_u32 s44, s44, 49152
    buffer_load_dwordx4 v24, s[64:67], s44 offen offset:0 lds
    buffer_load_dwordx4 v25, s[64:67], s44 offen offset:1024 lds
    buffer_load_dwordx4 v26, s[64:67], s44 offen offset:2048 lds
    s_mov_b32 m0, 18432
    s_add_u32 s44, s44, 49152
    buffer_load_dwordx4 v24, s[64:67], s44 offen offset:0 lds
    buffer_load_dwordx4 v25, s[64:67], s44 offen offset:1024 lds
    buffer_load_dwordx4 v26, s[64:67], s44 offen offset:2048 lds
    s_mov_b32 m0, 21504
    s_add_u32 s44, s44, 49152
    buffer_load_dwordx4 v24, s[64:67], s44 offen offset:0 lds
    buffer_load_dwordx4 v25, s[64:67], s44 offen offset:1024 lds
    buffer_load_dwordx4 v26, s[64:67], s44 offen offset:2048 lds
    s_waitcnt vmcnt(12)
    s_max_u32 s50, s50, 10
    v_mov_b32 v65, s50
    ds_write_b32 v64, v65
    s_mul_i32 s45, s43, 5
    s_lshr_b32 s45, s45, 3
    s_min_u32 s45, s45, 3
    s_mul_i32 s45, s45, 1536
    s_add_u32 s48, s45, 24576
    global_load_dwordx2 v[4:5], v6, s[36:37] sc1
    buffer_load_dwordx4 v[8:11], v7, s[4:7], s48 offen offset:0 sc1
    buffer_load_dwordx4 v[12:15], v7, s[4:7], s48 offen offset:1024 sc1
    buffer_load_dwordx4 v[16:19], v7, s[4:7], s48 offen offset:2048 sc1
    s_and_b32 s45, s43, 3
    s_mul_i32 s45, s45, 3
    s_and_b32 s101, s42, 7
    s_add_u32 s45, s45, s101
    s_lshr_b32 s101, s101, 1
    s_add_u32 s45, s45, s101
    s_sub_u32 s101, s45, 12
    s_cmp_ge_u32 s45, 12
    s_cselect_b32 s101, s101, s45
    s_lshl_b32 s101, s101, 10
    s_lshl_b32 s47, s42, 8
    s_add_u32 s47, s47, 4096
    s_waitcnt vmcnt(0)
    s_mov_b32 s56, 0
    s_branch L_w2chk_29
L_w2spin_28:
    s_waitcnt vmcnt(0)
    s_max_u32 s50, s50, 11
    v_mov_b32 v65, s50
    ds_write_b32 v64, v65
    s_sleep 6
    global_load_dwordx2 v[4:5], v6, s[36:37] sc1
    buffer_load_dwordx4 v[8:11], v7, s[4:7], s48 offen offset:0 sc1
    buffer_load_dwordx4 v[12:15], v7, s[4:7], s48 offen offset:1024 sc1
    buffer_load_dwordx4 v[16:19], v7, s[4:7], s48 offen offset:2048 sc1
    s_add_u32 s56, s56, 1
    s_cmp_gt_u32 s56, 0x10000
    s_waitcnt vmcnt(0)
    s_cbranch_scc1 L_w2ok_27
L_w2chk_29:
    v_cmp_eq_u32 vcc, 0, v4
    v_cmp_ne_u64 s[54:55], v[8:9], v[4:5]
    s_or_b64 vcc, vcc, s[54:55]
    v_cmp_ne_u64 s[54:55], v[10:11], v[4:5]
    s_or_b64 vcc, vcc, s[54:55]
    v_cmp_ne_u64 s[54:55], v[12:13], v[4:5]
    s_or_b64 vcc, vcc, s[54:55]
    v_cmp_ne_u64 s[54:55], v[14:15], v[4:5]
    s_or_b64 vcc, vcc, s[54:55]
    v_cmp_ne_u64 s[54:55], v[16:17], v[4:5]
    s_or_b64 vcc, vcc, s[54:55]
    v_cmp_ne_u64 s[54:55], v[18:19], v[4:5]
    s_or_b64 vcc, vcc, s[54:55]
    s_cbranch_scc1 L_w2spin_28
L_w2ok_27:
    s_waitcnt lgkmcnt(2)
    v_min3_u32 v60, v60, v61, v62
    v_min_u32 v60, v60, v63
    s_mov_b32 s51, 16
    v_readfirstlane_b32 s49, v60
    s_mov_b32 s52, 11
    s_cmp_ge_u32 s49, 16
    s_cbranch_scc1 L_relok_30
    s_call_b64 s[58:59], L_ld_slow
L_relok_30:
    s_add_u32 s44, s101, 0
    s_sub_u32 s45, s44, 12288
    s_cmp_ge_u32 s44, 12288
    s_cselect_b32 s44, s45, s44
    s_mov_b32 m0, 65536
    s_add_u32 s44, s44, s53
    buffer_load_dwordx4 v40, s[72:75], s44 offen offset:0 sc1 lds
    buffer_load_dwordx4 v41, s[72:75], s44 offen offset:1024 sc1 lds
    buffer_load_dwordx4 v42, s[72:75], s44 offen offset:2048 sc1 lds
    buffer_load_dwordx4 v43, s[72:75], s44 offen offset:3072 sc1 lds
    s_mov_b32 m0, 69632
    s_add_u32 s44, s44, 49152
    buffer_load_dwordx4 v40, s[72:75], s44 offen offset:0 sc1 lds
    buffer_load_dwordx4 v41, s[72:75], s44 offen offset:1024 sc1 lds
    buffer_load_dwordx4 v42, s[72:75], s44 offen offset:2048 sc1 lds
    buffer_load_dwordx4 v43, s[72:75], s44 offen offset:3072 sc1 lds
    s_waitcnt vmcnt(12)
    s_max_u32 s50, s50, 11
    v_mov_b32 v65, s50
    ds_write_b32 v64, v65
    s_mov_b32 m0, 73728
    s_add_u32 s44, s44, 49152
    buffer_load_dwordx4 v40, s[72:75], s44 offen offset:0 sc1 lds
    ds_read_b128 v[60:63], v66
    buffer_load_dwordx4 v41, s[72:75], s44 offen offset:1024 sc1 lds
    buffer_load_dwordx4 v42, s[72:75], s44 offen offset:2048 sc1 lds
    buffer_load_dwordx4 v43, s[72:75], s44 offen offset:3072 sc1 lds
    s_mov_b32 m0, 77824
    s_add_u32 s44, s44, 49152
    buffer_load_dwordx4 v40, s[72:75], s44 offen offset:0 sc1 lds
    buffer_load_dwordx4 v41, s[72:75], s44 offen offset:1024 sc1 lds
    buffer_load_dwordx4 v42, s[72:75], s44 offen offset:2048 sc1 lds
    buffer_load_dwordx4 v43, s[72:75], s44 offen offset:3072 sc1 lds
    s_mov_b32 m0, 24576
    s_add_u32 s44, s44, 49152
    buffer_load_dwordx4 v40, s[72:75], s44 offen offset:0 sc1 lds
    buffer_load_dwordx4 v41, s[72:75], s44 offen offset:1024 sc1 lds
    buffer_load_dwordx4 v42, s[72:75], s44 offen offset:2048 sc1 lds
    buffer_load_dwordx4 v43, s[72:75], s44 offen offset:3072 sc1 lds
    s_waitcnt lgkmcnt(0)
    v_min3_u32 v60, v60, v61, v62
    v_min_u32 v60, v60, v63
    s_mov_b32 s51, 17
    v_readfirstlane_b32 s49, v60
    s_mov_b32 s52, 12
    s_cmp_ge_u32 s49, 17
    s_cbranch_scc1 L_relok_31
    s_call_b64 s[58:59], L_ld_slow
L_relok_31:
    s_add_u32 s44, s101, 1024
    s_sub_u32 s45, s44, 12288
    s_cmp_ge_u32 s44, 12288
    s_cselect_b32 s44, s45, s44
    s_mov_b32 m0, 28672
    s_add_u32 s44, s44, s53
    buffer_load_dwordx4 v40, s[72:75], s44 offen offset:0 sc1 lds
    buffer_load_dwordx4 v41, s[72:75], s44 offen offset:1024 sc1 lds
    buffer_load_dwordx4 v42, s[72:75], s44 offen offset:2048 sc1 lds
    buffer_load_dwordx4 v43, s[72:75], s44 offen offset:3072 sc1 lds
    s_mov_b32 m0, 32768
    s_add_u32 s44, s44, 49152
    buffer_load_dwordx4 v40, s[72:75], s44 offen offset:0 sc1 lds
    buffer_load_dwordx4 v41, s[72:75], s44 offen offset:1024 sc1 lds
    buffer_load_dwordx4 v42, s[72:75], s44 offen offset:2048 sc1 lds
    buffer_load_dwordx4 v43, s[72:75], s44 offen offset:3072 sc1 lds
    s_mov_b32 m0, 81920
    s_add_u32 s44, s44, 49152
    buffer_load_dwordx4 v40, s[72:75], s44 offen offset:0 sc1 lds
    ds_read_b128 v[60:63], v66
    buffer_load_dwordx4 v41, s[72:75], s44 offen offset:1024 sc1 lds
    buffer_load_dwordx4 v42, s[72:75], s44 offen offset:2048 sc1 lds
    buffer_load_dwordx4 v43, s[72:75], s44 offen offset:3072 sc1 lds
    s_waitcnt vmcnt(12)
    s_max_u32 s50, s50, 12
    v_mov_b32 v65, s50
    ds_write_b32 v64, v65
    s_mov_b32 m0, 86016
    s_add_u32 s44, s44, 49152
    buffer_load_dwordx4 v40, s[72:75], s44 offen offset:0 sc1 lds
    buffer_load_dwordx4 v41, s[72:75], s44 offen offset:1024 sc1 lds
    buffer_load_dwordx4 v42, s[72:75], s44 offen offset:2048 sc1 lds
    buffer_load_dwordx4 v43, s[72:75], s44 offen offset:3072 sc1 lds
    s_mov_b32 m0, 90112
    s_add_u32 s44, s44, 49152
    buffer_load_dwordx4 v40, s[72:75], s44 offen offset:0 sc1 lds
    buffer_load_dwordx4 v41, s[72:75], s44 offen offset:1024 sc1 lds
    buffer_load_dwordx4 v42, s[72:75], s44 offen offset:2048 sc1 lds
    buffer_load_dwordx4 v43, s[72:75], s44 offen offset:3072 sc1 lds
    s_waitcnt lgkmcnt(1)
    v_min3_u32 v60, v60, v61, v62
    v_min_u32 v60, v60, v63
    s_mov_b32 s51, 19
    v_readfirstlane_b32 s49, v60
    s_mov_b32 s52, 13
    s_cmp_ge_u32 s49, 19
    s_cbranch_scc1 L_relok_32
    s_call_b64 s[58:59], L_ld_slow
L_relok_32:
    s_add_u32 s44, s101, 2048
    s_sub_u32 s45, s44, 12288
    s_cmp_ge_u32 s44, 12288
    s_cselect_b32 s44, s45, s44
    s_mov_b32 m0, 94208
    s_add_u32 s44, s44, s53
    buffer_load_dwordx4 v40, s[72:75], s44 offen offset:0 sc1 lds
    buffer_load_dwordx4 v41, s[72:75], s44 offen offset:1024 sc1 lds
    buffer_load_dwordx4 v42, s[72:75], s44 offen offset:2048 sc1 lds
    buffer_load_dwordx4 v43, s[72:75], s44 offen offset:3072 sc1 lds
    s_mov_b32 m0, 36864
    s_add_u32 s44, s44, 49152
    buffer_load_dwordx4 v40, s[72:75], s44 offen offset:0 sc1 lds
    buffer_load_dwordx4 v41, s[72:75], s44 offen offset:1024 sc1 lds
    buffer_load_dwordx4 v42, s[72:75], s44 offen offset:2048 sc1 lds
    buffer_load_dwordx4 v43, s[72:75], s44 offen offset:3072 sc1 lds
    s_mov_b32 m0, 40960
    s_add_u32 s44, s44, 49152
    buffer_load_dwordx4 v40, s[72:75], s44 offen offset:0 sc1 lds
    ds_read_b128 v[60:63], v66
    buffer_load_dwordx4 v41, s[72:75], s44 offen offset:1024 sc1 lds
    buffer_load_dwordx4 v42, s[72:75], s44 offen offset:2048 sc1 lds
    buffer_load_dwordx4 v43, s[72:75], s44 offen offset:3072 sc1 lds
    s_waitcnt vmcnt(12)
    s_max_u32 s50, s50, 13
    v_mov_b32 v65, s50
    ds_write_b32 v64, v65
    s_mov_b32 m0, 45056
    s_add_u32 s44, s44, 49152
    buffer_load_dwordx4 v40, s[72:75], s44 offen offset:0 sc1 lds
    buffer_load_dwordx4 v41, s[72:75], s44 offen offset:1024 sc1 lds
    buffer_load_dwordx4 v42, s[72:75], s44 offen offset:2048 sc1 lds
    buffer_load_dwordx4 v43, s[72:75], s44 offen offset:3072 sc1 lds
    s_mov_b32 m0, 49152
    s_add_u32 s44, s44, 49152
    buffer_load_dwordx4 v40, s[72:75], s44 offen offset:0 sc1 lds
    buffer_load_dwordx4 v41, s[72:75], s44 offen offset:1024 sc1 lds
    buffer_load_dwordx4 v42, s[72:75], s44 offen offset:2048 sc1 lds
    buffer_load_dwordx4 v43, s[72:75], s44 offen offset:3072 sc1 lds
    s_waitcnt lgkmcnt(1)
    v_min3_u32 v60, v60, v61, v62
    v_min_u32 v60, v60, v63
    s_mov_b32 s51, 20
    v_readfirstlane_b32 s49, v60
    s_mov_b32 s52, 14
    s_cmp_ge_u32 s49, 20
    s_cbranch_scc1 L_relok_33
    s_call_b64 s[58:59], L_ld_slow
L_relok_33:
    s_add_u32 s44, s101, 3072
    s_sub_u32 s45, s44, 12288
    s_cmp_ge_u32 s44, 12288
    s_cselect_b32 s44, s45, s44
    s_mov_b32 m0, 53248
    s_add_u32 s44, s44, s53
    buffer_load_dwordx4 v40, s[72:75], s44 offen offset:0 sc1 lds
    buffer_load_dwordx4 v41, s[72:75], s44 offen offset:1024 sc1 lds
    buffer_load_dwordx4 v42, s[72:75], s44 offen offset:2048 sc1 lds
    buffer_load_dwordx4 v43, s[72:75], s44 offen offset:3072 sc1 lds
    s_mov_b32 m0, 57344
    s_add_u32 s44, s44, 49152
    buffer_load_dwordx4 v40, s[72:75], s44 offen offset:0 sc1 lds
    buffer_load_dwordx4 v41, s[72:75], s44 offen offset:1024 sc1 lds
    buffer_load_dwordx4 v42, s[72:75], s44 offen offset:2048 sc1 lds
    buffer_load_dwordx4 v43, s[72:75], s44 offen offset:3072 sc1 lds
    s_mov_b32 m0, 61440
    s_add_u32 s44, s44, 49152
    buffer_load_dwordx4 v40, s[72:75], s44 offen offset:0 sc1 lds
    buffer_load_dwordx4 v41, s[72:75], s44 offen offset:1024 sc1 lds
    buffer_load_dwordx4 v42, s[72:75], s44 offen offset:2048 sc1 lds
    buffer_load_dwordx4 v43, s[72:75], s44 offen offset:3072 sc1 lds
    s_waitcnt vmcnt(12)
    s_max_u32 s50, s50, 14
    v_mov_b32 v65, s50
    ds_write_b32 v64, v65
    s_mov_b32 m0, 0
    s_add_u32 s44, s44, 49152
    buffer_load_dwordx4 v40, s[72:75], s44 offen offset:0 sc1 lds
    buffer_load_dwordx4 v41, s[72:75], s44 offen offset:1024 sc1 lds
    buffer_load_dwordx4 v42, s[72:75], s44 offen offset:2048 sc1 lds
    buffer_load_dwordx4 v43, s[72:75], s44 offen offset:3072 sc1 lds
    s_mov_b32 m0, 4096
    s_add_u32 s44, s44, 49152
    buffer_load_dwordx4 v40, s[72:75], s44 offen offset:0 sc1 lds
    buffer_load_dwordx4 v41, s[72:75], s44 offen offset:1024 sc1 lds
    buffer_load_dwordx4 v42, s[72:75], s44 offen offset:2048 sc1 lds
    buffer_load_dwordx4 v43, s[72:75], s44 offen offset:3072 sc1 lds
    s_waitcnt vmcnt(0)
    s_max_u32 s50, s50, 15
    v_mov_b32 v65, s50
    ds_write_b32 v64, v65
    ds_read_b128 v[60:63], v66
    s_waitcnt lgkmcnt(0)
    v_min3_u32 v60, v60, v61, v62
    v_min_u32 v60, v60, v63
    s_mov_b32 s51, 22
    v_readfirstlane_b32 s49, v60
    s_mov_b32 s52, 15
    s_cmp_ge_u32 s49, 22
    s_cbranch_scc1 L_relok_34
    s_call_b64 s[58:59], L_ld_slow
L_relok_34:
    buffer_load_dwordx4 v[8:11], v67, s[4:7], s47 offen offset:0 sc1
    s_waitcnt vmcnt(0)
    s_mov_b32 s56, 0
    s_branch L_pchk_37
L_pspin_36:
    s_sleep 6
    buffer_load_dwordx4 v[8:11], v67, s[4:7], s47 offen offset:0 sc1
    s_add_u32 s56, s56, 1
    s_cmp_gt_u32 s56, 0x10000
    s_waitcnt vmcnt(0)
    s_cbranch_scc1 L_pok_35
L_pchk_37:
    v_cmp_ne_u64 vcc, v[8:9], v[4:5]
    v_cmp_ne_u64 s[54:55], v[10:11], v[4:5]
    s_or_b64 vcc, vcc, s[54:55]
    s_cbranch_scc1 L_pspin_36
L_pok_35:
    s_max_u32 s50, s50, 16
    v_mov_b32 v65, s50
    ds_write_b32 v64, v65
    ds_read_b128 v[60:63], v66
    s_add_u32 s44, s101, 7168
    s_sub_u32 s45, s44, 12288
    s_cmp_ge_u32 s44, 12288
    s_cselect_b32 s44, s45, s44
    s_mov_b32 m0, 8192
    s_add_u32 s44, s44, s53
    buffer_load_dwordx4 v40, s[72:75], s44 offen offset:0 sc1 lds
    buffer_load_dwordx4 v41, s[72:75], s44 offen offset:1024 sc1 lds
    buffer_load_dwordx4 v42, s[72:75], s44 offen offset:2048 sc1 lds
    buffer_load_dwordx4 v43, s[72:75], s44 offen offset:3072 sc1 lds
    s_mov_b32 m0, 12288
    s_add_u32 s44, s44, 49152
    buffer_load_dwordx4 v40, s[72:75], s44 offen offset:0 sc1 lds
    buffer_load_dwordx4 v41, s[72:75], s44 offen offset:1024 sc1 lds
    buffer_load_dwordx4 v42, s[72:75], s44 offen offset:2048 sc1 lds
    buffer_load_dwordx4 v43, s[72:75], s44 offen offset:3072 sc1 lds
    s_mov_b32 m0, 16384
    s_add_u32 s44, s44, 49152
    buffer_load_dwordx4 v40, s[72:75], s44 offen offset:0 sc1 lds
    ds_read_b128 v[60:63], v66
    buffer_load_dwordx4 v41, s[72:75], s44 offen offset:1024 sc1 lds
    buffer_load_dwordx4 v42, s[72:75], s44 offen offset:2048 sc1 lds
    buffer_load_dwordx4 v43, s[72:75], s44 offen offset:3072 sc1 lds
    s_mov_b32 m0, 20480
    s_add_u32 s44, s44, 49152
    buffer_load_dwordx4 v40, s[72:75], s44 offen offset:0 sc1 lds
    buffer_load_dwordx4 v41, s[72:75], s44 offen offset:1024 sc1 lds
    buffer_load_dwordx4 v42, s[72:75], s44 offen offset:2048 sc1 lds
    buffer_load_dwordx4 v43, s[72:75], s44 offen offset:3072 sc1 lds
    s_mov_b32 m0, 65536
    s_add_u32 s44, s44, 49152
    buffer_load_dwordx4 v40, s[72:75], s44 offen offset:0 sc1 lds
    buffer_load_dwordx4 v41, s[72:75], s44 offen offset:1024 sc1 lds
    buffer_load_dwordx4 v42, s[72:75], s44 offen offset:2048 sc1 lds
    buffer_load_dwordx4 v43, s[72:75], s44 offen offset:3072 sc1 lds
    s_waitcnt lgkmcnt(0)
    v_min3_u32 v60, v60, v61, v62
    v_min_u32 v60, v60, v63
    s_mov_b32 s51, 23
    v_readfirstlane_b32 s49, v60
    s_mov_b32 s52, 17
    s_cmp_ge_u32 s49, 23
    s_cbranch_scc1 L_relok_38
    s_call_b64 s[58:59], L_ld_slow
L_relok_38:
    s_add_u32 s44, s101, 8192
    s_sub_u32 s45, s44, 12288
    s_cmp_ge_u32 s44, 12288
    s_cselect_b32 s44, s45, s44
    s_mov_b32 m0, 69632
    s_add_u32 s44, s44, s53
    buffer_load_dwordx4 v40, s[72:75], s44 offen offset:0 sc1 lds
    buffer_load_dwordx4 v41, s[72:75], s44 offen offset:1024 sc1 lds
    buffer_load_dwordx4 v42, s[72:75], s44 offen offset:2048 sc1 lds
    buffer_load_dwordx4 v43, s[72:75], s44 offen offset:3072 sc1 lds
    s_mov_b32 m0, 73728
    s_add_u32 s44, s44, 49152
    buffer_load_dwordx4 v40, s[72:75], s44 offen offset:0 sc1 lds
    buffer_load_dwordx4 v41, s[72:75], s44 offen offset:1024 sc1 lds
    buffer_load_dwordx4 v42, s[72:75], s44 offen offset:2048 sc1 lds
    buffer_load_dwordx4 v43, s[72:75], s44 offen offset:3072 sc1 lds
    s_mov_b32 m0, 77824
    s_add_u32 s44, s44, 49152
    buffer_load_dwordx4 v40, s[72:75], s44 offen offset:0 sc1 lds
    ds_read_b128 v[60:63], v66
    buffer_load_dwordx4 v41, s[72:75], s44 offen offset:1024 sc1 lds
    buffer_load_dwordx4 v42, s[72:75], s44 offen offset:2048 sc1 lds
    buffer_load_dwordx4 v43, s[72:75], s44 offen offset:3072 sc1 lds
    s_waitcnt vmcnt(12)
    s_max_u32 s50, s50, 17
    v_mov_b32 v65, s50
    ds_write_b32 v64, v65
    s_mov_b32 m0, 24576
    s_add_u32 s44, s44, 49152
    buffer_load_dwordx4 v40, s[72:75], s44 offen offset:0 sc1 lds
    buffer_load_dwordx4 v41, s[72:75], s44 offen offset:1024 sc1 lds
    buffer_load_dwordx4 v42, s[72:75], s44 offen offset:2048 sc1 lds
    buffer_load_dwordx4 v43, s[72:75], s44 offen offset:3072 sc1 lds
    s_mov_b32 m0, 28672
    s_add_u32 s44, s44, 49152
    buffer_load_dwordx4 v40, s[72:75], s44 offen offset:0 sc1 lds
    buffer_load_dwordx4 v41, s[72:75], s44 offen offset:1024 sc1 lds
    buffer_load_dwordx4 v42, s[72:75], s44 offen offset:2048 sc1 lds
    buffer_load_dwordx4 v43, s[72:75], s44 offen offset:3072 sc1 lds
    s_waitcnt lgkmcnt(1)
    v_min3_u32 v60, v60, v61, v62
    v_min_u32 v60, v60, v63
    s_mov_b32 s51, 24
    v_readfirstlane_b32 s49, v60
    s_mov_b32 s52, 18
    s_cmp_ge_u32 s49, 24
    s_cbranch_scc1 L_relok_39
    s_call_b64 s[58:59], L_ld_slow
L_relok_39:
    s_add_u32 s44, s101, 9216
    s_sub_u32 s45, s44, 12288
    s_cmp_ge_u32 s44, 12288
    s_cselect_b32 s44, s45, s44
    s_mov_b32 m0, 32768
    s_add_u32 s44, s44, s53
    buffer_load_dwordx4 v40, s[72:75], s44 offen offset:0 sc1 lds
    buffer_load_dwordx4 v41, s[72:75], s44 offen offset:1024 sc1 lds
    buffer_load_dwordx4 v42, s[72:75], s44 offen offset:2048 sc1 lds
    buffer_load_dwordx4 v43, s[72:75], s44 offen offset:3072 sc1 lds
    s_mov_b32 m0, 94208
    s_add_u32 s44, s44, 49152
    buffer_load_dwordx4 v40, s[72:75], s44 offen offset:0 sc1 lds
    buffer_load_dwordx4 v41, s[72:75], s44 offen offset:1024 sc1 lds
    buffer_load_dwordx4 v42, s[72:75], s44 offen offset:2048 sc1 lds
    buffer_load_dwordx4 v43, s[72:75], s44 offen offset:3072 sc1 lds
    s_mov_b32 m0, 36864
    s_add_u32 s44, s44, 49152
    buffer_load_dwordx4 v40, s[72:75], s44 offen offset:0 sc1 lds
    ds_read_b128 v[60:63], v66
    buffer_load_dwordx4 v41, s[72:75], s44 offen offset:1024 sc1 lds
    buffer_load_dwordx4 v42, s[72:75], s44 offen offset:2048 sc1 lds
    buffer_load_dwordx4 v43, s[72:75], s44 offen offset:3072 sc1 lds
    s_waitcnt vmcnt(12)
    s_max_u32 s50, s50, 18
    v_mov_b32 v65, s50
    ds_write_b32 v64, v65
    s_mov_b32 m0, 40960
    s_add_u32 s44, s44, 49152
    buffer_load_dwordx4 v40, s[72:75], s44 offen offset:0 sc1 lds
    buffer_load_dwordx4 v41, s[72:75], s44 offen offset:1024 sc1 lds
    buffer_load_dwordx4 v42, s[72:75], s44 offen offset:2048 sc1 lds
    buffer_load_dwordx4 v43, s[72:75], s44 offen offset:3072 sc1 lds
    s_mov_b32 m0, 45056
    s_add_u32 s44, s44, 49152
    buffer_load_dwordx4 v40, s[72:75], s44 offen offset:0 sc1 lds
    buffer_load_dwordx4 v41, s[72:75], s44 offen offset:1024 sc1 lds
    buffer_load_dwordx4 v42, s[72:75], s44 offen offset:2048 sc1 lds
    buffer_load_dwordx4 v43, s[72:75], s44 offen offset:3072 sc1 lds
    s_waitcnt lgkmcnt(1)
    v_min3_u32 v60, v60, v61, v62
    v_min_u32 v60, v60, v63
    s_mov_b32 s51, 25
    v_readfirstlane_b32 s49, v60
    s_mov_b32 s52, 19
    s_cmp_ge_u32 s49, 25
    s_cbranch_scc1 L_relok_40
    s_call_b64 s[58:59], L_ld_slow
L_relok_40:
    s_add_u32 s44, s101, 10240
    s_sub_u32 s45, s44, 12288
    s_cmp_ge_u32 s44, 12288
    s_cselect_b32 s44, s45, s44
    s_mov_b32 m0, 49152
    s_add_u32 s44, s44, s53
    buffer_load_dwordx4 v40, s[72:75], s44 offen offset:0 sc1 lds
    buffer_load_dwordx4 v41, s[72:75], s44 offen offset:1024 sc1 lds
    buffer_load_dwordx4 v42, s[72:75], s44 offen offset:2048 sc1 lds
    buffer_load_dwordx4 v43, s[72:75], s44 offen offset:3072 sc1 lds
    s_mov_b32 m0, 53248
    s_add_u32 s44, s44, 49152
    buffer_load_dwordx4 v40, s[72:75], s44 offen offset:0 sc1 lds
    buffer_load_dwordx4 v41, s[72:75], s44 offen offset:1024 sc1 lds
    buffer_load_dwordx4 v42, s[72:75], s44 offen offset:2048 sc1 lds
    buffer_load_dwordx4 v43, s[72:75], s44 offen offset:3072 sc1 lds
    s_mov_b32 m0, 57344
    s_add_u32 s44, s44, 49152
    buffer_load_dwordx4 v40, s[72:75], s44 offen offset:0 sc1 lds
    buffer_load_dwordx4 v41, s[72:75], s44 offen offset:1024 sc1 lds
    buffer_load_dwordx4 v42, s[72:75], s44 offen offset:2048 sc1 lds
    buffer_load_dwordx4 v43, s[72:75], s44 offen offset:3072 sc1 lds
    s_waitcnt vmcnt(12)
    s_max_u32 s50, s50, 19
    v_mov_b32 v65, s50
    ds_write_b32 v64, v65
    s_mov_b32 m0, 61440
    s_add_u32 s44, s44, 49152
    buffer_load_dwordx4 v40, s[72:75], s44 offen offset:0 sc1 lds
    buffer_load_dwordx4 v41, s[72:75], s44 offen offset:1024 sc1 lds
    buffer_load_dwordx4 v42, s[72:75], s44 offen offset:2048 sc1 lds
    buffer_load_dwordx4 v43, s[72:75], s44 offen offset:3072 sc1 lds
    s_mov_b32 m0, 0
    s_add_u32 s44, s44, 49152
    buffer_load_dwordx4 v40, s[72:75], s44 offen offset:0 sc1 lds
    buffer_load_dwordx4 v41, s[72:75], s44 offen offset:1024 sc1 lds
    buffer_load_dwordx4 v42, s[72:75], s44 offen offset:2048 sc1 lds
    buffer_load_dwordx4 v43, s[72:75], s44 offen offset:3072 sc1 lds
    s_add_u32 s68, s38, 0xaa8000
    s_addc_u32 s69, s39, 0
    s_and_b32 s69, s69, 0xffff
    s_mov_b32 s70, 0x2a8000
    s_mov_b32 s71, 0x00020000
    v_lshrrev_b32 v1, 3, v0
    v_and_b32 v2, 7, v0
    v_mul_u32_u24 v36, 4352, v1
    v_lshl_add_u32 v36, v2, 4, v36
    v_min_u32 v67, 624, v7
    s_mul_i32 s47, s43, 640
    s_add_u32 s47, s47, 16384
    buffer_load_dwordx4 v[8:11], v67, s[4:7], s47 offen offset:0 sc1
    s_waitcnt vmcnt(1)
    s_max_u32 s50, s50, 20
    v_mov_b32 v65, s50
    ds_write_b32 v64, v65
    s_waitcnt vmcnt(0)
    s_mov_b32 s56, 0
    s_branch L_pchk_43
L_pspin_42:
    s_sleep 6
    buffer_load_dwordx4 v[8:11], v67, s[4:7], s47 offen offset:0 sc1
    s_add_u32 s56, s56, 1
    s_cmp_gt_u32 s56, 0x10000
    s_waitcnt vmcnt(0)
    s_cbranch_scc1 L_pok_41
L_pchk_43:
    v_cmp_ne_u64 vcc, v[8:9], v[4:5]
    v_cmp_ne_u64 s[54:55], v[10:11], v[4:5]
    s_or_b64 vcc, vcc, s[54:55]
    s_cbranch_scc1 L_pspin_42
L_pok_41:
    s_mul_i32 s44, s43, 348160
    s_lshl_b32 s45, s42, 7
    s_add_u32 s44, s44, s45
    s_mov_b32 m0, 81920
    s_nop 0
    buffer_load_dwordx4 v36, s[68:71], s44 offen sc1 lds
    s_mov_b32 m0, 82944
    s_add_u32 s44, s44, 34816
    buffer_load_dwordx4 v36, s[68:71], s44 offen sc1 lds
    s_mov_b32 m0, 83968
    s_add_u32 s44, s44, 34816
    buffer_load_dwordx4 v36, s[68:71], s44 offen sc1 lds
    s_mov_b32 m0, 84992
    s_add_u32 s44, s44, 34816
    buffer_load_dwordx4 v36, s[68:71], s44 offen sc1 lds
    s_mov_b32 m0, 86016
    s_add_u32 s44, s44, 34816
    buffer_load_dwordx4 v36, s[68:71], s44 offen sc1 lds
    s_mov_b32 m0, 87040
    s_add_u32 s44, s44, 34816
    buffer_load_dwordx4 v36, s[68:71], s44 offen sc1 lds
    s_mov_b32 m0, 88064
    s_add_u32 s44, s44, 34816
    buffer_load_dwordx4 v36, s[68:71], s44 offen sc1 lds
    s_mov_b32 m0, 89088
    s_add_u32 s44, s44, 34816
    buffer_load_dwordx4 v36, s[68:71], s44 offen sc1 lds
    s_mov_b32 m0, 90112
    s_add_u32 s44, s44, 34816
    buffer_load_dwordx4 v36, s[68:71], s44 offen sc1 lds
    s_mov_b32 m0, 91136
    s_add_u32 s44, s44, 34816
    buffer_load_dwordx4 v36, s[68:71], s44 offen sc1 lds
    s_waitcnt vmcnt(0)
    s_max_u32 s50, s50, 21
    v_mov_b32 v65, s50
    ds_write_b32 v64, v65
    s_endpgm
L_ld_slow:
    s_mov_b32 s56, 0
L_ld_slow_loop:
    s_cmp_lg_u32 s56, 3
    s_cbranch_scc1 L_ld_slow_nodrain
    s_waitcnt vmcnt(0)
    s_max_u32 s50, s50, s52
    v_mov_b32 v65, s50
    ds_write_b32 v64, v65
L_ld_slow_nodrain:
    ds_read_b128 v[60:63], v66
    s_add_u32 s56, s56, 1
    s_waitcnt lgkmcnt(0)
    v_min3_u32 v60, v60, v61, v62
    v_min_u32 v60, v60, v63
    s_cmp_gt_u32 s56, 0x100000
    v_readfirstlane_b32 s49, v60
    s_cbranch_scc1 L_ld_slow_ret
    s_cmp_lt_u32 s49, s51
    s_cbranch_scc1 L_ld_slow_loop
L_ld_slow_ret:
    s_setpc_b64 s[58:59]
L_compute:
    v_lshlrev_b32 v1, 2, v0
    v_add_u32 v12, 159808, v1
    v_mov_b32 v6, 0
    s_setprio 1
    s_lshl_b32 s44, s3, 2
    s_add_u32 s44, s44, 159760
    v_mov_b32 v2, s44
    v_cmp_eq_u32 vcc, 0, v0
    v_mov_b32 v14, 159744
    s_mov_b32 s48, 0
    v_cndmask_b32 v12, v12, v2, vcc
    s_bfe_u32 s40, s2, 0x20001
    s_lshl_b32 s40, s40, 2
    s_lshr_b32 s44, s2, 6
    s_add_u32 s40, s40, s44
    s_and_b32 s41, s2, 1
    s_lshl_b32 s41, s41, 3
    s_bfe_u32 s44, s2, 0x30003
    s_add_u32 s41, s41, s44
    v_lshrrev_b32 v1, 4, v0
    v_lshrrev_b32 v2, 3, v0
    v_and_b32 v3, 7, v0
    v_xor_b32 v3, v3, v1
    v_mul_u32_u24 v100, 1280, v2
    v_lshl_add_u32 v100, v3, 4, v100
    v_xor_b32 v101, 64, v100
    v_add_u32 v102, 18432, v100
    v_add_u32 v103, 27648, v101
    v_add_u32 v101, 9216, v101
    s_and_b32 s46, s40, 3
    s_mul_i32 s46, s46, 3
    s_add_u32 s46, s46, s41
    s_sub_u32 s45, s46, 10
    s_cmp_ge_u32 s46, 10
    s_cselect_b32 s46, s45, s46
    s_sub_u32 s45, s46, 10
    s_cmp_ge_u32 s46, 10
    s_cselect_b32 s46, s45, s46
    s_lshl2_add_u32 s44, s40, s3
    s_waitcnt lgkmcnt(0)
    s_mul_i32 s16, s44, 40960
    s_lshl_b32 s18, s3, 12
    s_lshl_b32 s17, s46, 7
    s_mov_b32 s12, s8
    s_and_b32 s13, s9, 0xffff
    s_mov_b32 s14, 0x280000
    s_mov_b32 s15, 0x00020000
    s_add_u32 m0, s18, 49152
    s_add_u32 s19, s16, s17
    buffer_load_dwordx4 v100, s[12:15], s19 offen offset:0 lds
    s_add_u32 s17, s17, 128
    s_cmp_ge_u32 s17, 1280
    s_cselect_b32 s17, 0, s17
    buffer_load_dwordx4 v101, s[12:15], s19 offen offset:1024 lds
    buffer_load_dwordx4 v102, s[12:15], s19 offen offset:2048 lds
    buffer_load_dwordx4 v103, s[12:15], s19 offen offset:3072 lds
    s_add_u32 m0, s18, 65536
    s_add_u32 s19, s16, s17
    buffer_load_dwordx4 v100, s[12:15], s19 offen offset:0 lds
    s_add_u32 s17, s17, 128
    s_cmp_ge_u32 s17, 1280
    s_cselect_b32 s17, 0, s17
    buffer_load_dwordx4 v101, s[12:15], s19 offen offset:1024 lds
    buffer_load_dwordx4 v102, s[12:15], s19 offen offset:2048 lds
    buffer_load_dwordx4 v103, s[12:15], s19 offen offset:3072 lds
    s_add_u32 m0, s18, 81920
    s_add_u32 s19, s16, s17
    buffer_load_dwordx4 v100, s[12:15], s19 offen offset:0 lds
    s_add_u32 s17, s17, 128
    s_cmp_ge_u32 s17, 1280
    s_cselect_b32 s17, 0, s17
    buffer_load_dwordx4 v101, s[12:15], s19 offen offset:1024 lds
    buffer_load_dwordx4 v102, s[12:15], s19 offen offset:2048 lds
    buffer_load_dwordx4 v103, s[12:15], s19 offen offset:3072 lds
    s_bfe_u32 s42, s2, 0x20001
    s_lshl_b32 s42, s42, 3
    s_lshr_b32 s44, s2, 5
    s_add_u32 s42, s42, s44
    s_and_b32 s43, s2, 1
    s_lshl_b32 s43, s43, 2
    s_bfe_u32 s44, s2, 0x20003
    s_add_u32 s43, s43, s44
    v_lshlrev_b32 v7, 4, v0
    v_and_b32 v1, 31, v0
    v_lshrrev_b32 v2, 5, v0
    v_lshlrev_b32 v3, 1, v1
    s_mul_i32 s44, s41, 192
    v_add_u32 v3, s44, v3
    global_load_ushort v28, v3, s[30:31] offset:0
    global_load_ushort v29, v3, s[30:31] offset:64
    global_load_ushort v30, v3, s[30:31] offset:128
    s_lshl_b32 s44, s3, 12
    s_add_u32 s44, s44, 49152
    v_bfe_u32 v3, v0, 1, 3
    v_xor_b32 v3, v3, v2
    v_lshlrev_b32 v3, 4, v3
    v_lshl_add_u32 v3, v1, 7, v3
    v_add_u32 v3, s44, v3
    s_add_u32 s45, s3, 0
    s_and_b32 s45, s45, 3
    s_lshl_b32 s45, s45, 5
    v_xor_b32 v16, s45, v3
    s_add_u32 s45, s3, 1
    s_and_b32 s45, s45, 3
    s_lshl_b32 s45, s45, 5
    v_xor_b32 v17, s45, v3
    s_add_u32 s45, s3, 2
    s_and_b32 s45, s45, 3
    s_lshl_b32 s45, s45, 5
    v_xor_b32 v18, s45, v3
    s_add_u32 s45, s3, 3
    s_and_b32 s45, s45, 3
    s_lshl_b32 s45, s45, 5
    v_xor_b32 v19, s45, v3
    v_bfe_u32 v3, v0, 2, 2
    v_lshl_add_u32 v3, v2, 3, v3
    v_mul_u32_u24 v3, 192, v3
    v_bfe_u32 v24, v0, 4, 1
    v_lshl_add_u32 v3, v24, 5, v3
    v_and_b32 v25, 3, v0
    v_lshl_add_u32 v3, v25, 3, v3
    s_add_u32 s45, s3, 0
    s_and_b32 s45, s45, 3
    s_mul_i32 s45, s45, 3072
    v_add_u32 v20, s45, v3
    s_add_u32 s45, s3, 1
    s_and_b32 s45, s45, 3
    s_mul_i32 s45, s45, 3072
    v_add_u32 v21, s45, v3
    s_add_u32 s45, s3, 2
    s_and_b32 s45, s45, 3
    s_mul_i32 s45, s45, 3072
    v_add_u32 v22, s45, v3
    s_add_u32 s45, s3, 3
    s_and_b32 s45, s45, 3
    s_mul_i32 s45, s45, 3072
    v_add_u32 v23, s45, v3
    v_mov_b32 v36, 0x3f803f80
    v_mov_b32 v37, 0x3f803f80
    v_lshlrev_b32 v26, 4, v2
    v_lshl_add_u32 v26, v24, 2, v26
    v_bfe_u32 v3, v0, 2, 2
    v_add_u32 v26, v26, v3
    v_lshlrev_b32 v26, 8, v26
    v_lshl_add_u32 v26, v25, 3, v26
    s_lshl_b32 s44, s3, 6
    v_add_u32 v26, s44, v26
    s_mul_i32 s44, s2, 13108
    s_lshr_b32 s44, s44, 16
    s_mul_i32 s45, s44, 5
    s_sub_u32 s45, s2, s45
    s_cmp_ge_u32 s2, 240
    s_cselect_b32 s45, 5, s45
    s_cselect_b32 s44, 0, s44
    s_lshl2_add_u32 s46, s45, s3
    s_mul_i32 s46, s46, 98304
    s_lshl_b32 s47, s44, 10
    s_add_u32 s46, s46, s47
    s_mul_i32 s51, s45, 48
    s_add_u32 s51, s51, s44
    s_lshl2_add_u32 s51, s51, s3
    s_lshl_b32 s51, s51, 3
    s_add_u32 s51, s51, 24576
    s_add_u32 s72, s38, 0x600000
    s_addc_u32 s73, s39, 0
    s_and_b32 s73, s73, 0xffff
    s_mov_b32 s74, 0x1e0000
    s_mov_b32 s75, 0x00020000
    s_add_u32 s64, s38, 0x7ec000
    s_addc_u32 s65, s39, 0
    s_and_b32 s65, s65, 0xffff
    s_mov_b32 s66, 0xb000
    s_mov_b32 s67, 0x00020000
    s_add_u32 s60, s38, 0x0
    s_addc_u32 s61, s39, 0
    s_and_b32 s61, s61, 0xffff
    s_mov_b32 s62, 0x600000
    s_mov_b32 s63, 0x00020000
    s_add_u32 s68, s38, 0x7e0000
    s_addc_u32 s69, s39, 0
    s_and_b32 s69, s69, 0xffff
    s_mov_b32 s70, 0x8000
    s_mov_b32 s71, 0x00020000
    s_add_u32 s4, s38, 0xaa8000
    s_addc_u32 s5, s39, 0
    s_and_b32 s5, s5, 0xffff
    s_mov_b32 s6, 0x2a8000
    s_mov_b32 s7, 0x00020000
    v_mul_u32_u24 v24, 3072, v24
    v_and_b32 v3, 15, v0
    v_add_u32 v24, v24, v3
    v_lshl_add_u32 v24, v2, 4, v24
    v_lshlrev_b32 v24, 4, v24
    s_lshl2_add_u32 s45, s40, s3
    s_lshl_b32 s44, s45, 9
    v_lshlrev_b32 v25, 4, v1
    v_add_u32 v25, s44, v25
    s_lshr_b32 s44, s45, 1
    s_lshl_b32 s49, s44, 5
    s_and_b32 s44, s45, 1
    s_add_u32 s49, s49, s44
    s_lshl_b32 s44, s41, 1
    s_add_u32 s49, s49, s44
    s_lshl_b32 s49, s49, 3
    s_add_u32 s49, s49, 4096
    s_mul_i32 s45, s45, 96
    s_mul_i32 s47, s41, 3
    s_add_u32 s47, s47, s45
    s_lshl_b32 s47, s47, 10
    s_mov_b32 s56, 0x3fb8aa3b
    s_mov_b32 s57, 0x3fb8aa3b
    s_mov_b32 s58, 2.0
    s_mov_b32 s59, 2.0
    v_mov_b32 v192, 0
    v_mov_b32 v193, 0
    v_mov_b32 v194, 0
    v_mov_b32 v195, 0
    v_mov_b32 v196, 0
    v_mov_b32 v197, 0
    v_mov_b32 v198, 0
    v_mov_b32 v199, 0
    v_mov_b32 v200, 0
    v_mov_b32 v201, 0
    v_mov_b32 v202, 0
    v_mov_b32 v203, 0
    v_mov_b32 v204, 0
    v_mov_b32 v205, 0
    v_mov_b32 v206, 0
    v_mov_b32 v207, 0
    v_lshlrev_b32 v27, 2, v1
    v_add_u32 v27, 160256, v27
    v_bfe_u32 v216, v0, 1, 1
    s_lshl_b32 s44, s3, 1
    v_add_u32 v216, s44, v216
    v_bfe_u32 v3, v0, 3, 1
    v_xor_b32 v216, v216, v3
    v_lshlrev_b32 v216, 4, v216
    v_and_b32 v3, 1, v0
    v_lshl_add_u32 v216, v3, 3, v216
    v_bfe_u32 v3, v0, 2, 2
    v_lshl_add_u32 v216, v3, 7, v216
    v_mul_u32_u24 v220, 17408, v3
    v_lshrrev_b32 v3, 4, v0
    v_lshl_add_u32 v216, v3, 12, v216
    v_add_u32 v216, 65536, v216
    v_xor_b32 v217, 32, v216
    v_xor_b32 v218, 64, v216
    v_xor_b32 v219, 96, v216
    v_lshl_add_u32 v220, v3, 6, v220
    v_and_b32 v3, 3, v0
    v_lshl_add_u32 v220, v3, 4, v220
    s_and_b32 s44, s40, 3
    s_mul_i32 s44, s44, 3
    s_add_u32 s44, s44, s41
    s_sub_u32 s45, s44, 10
    s_cmp_ge_u32 s44, 10
    s_cselect_b32 s44, s45, s44
    s_sub_u32 s45, s44, 10
    s_cmp_ge_u32 s44, 10
    s_cselect_b32 s44, s45, s44
    s_add_u32 s44, s44, 1
    s_cmp_ge_u32 s44, 10
    s_cselect_b32 s44, 0, s44
    s_cmp_ge_u32 s41, 10
    s_cselect_b32 s44, 10, s44
    s_lshl2_add_u32 s44, s44, s3
    s_mul_i32 s55, s44, 69632
    s_lshl_b32 s45, s40, 8
    s_add_u32 s55, s55, s45
    s_lshl4_add_u32 s26, s44, s40
    s_lshl_b32 s26, s26, 3
    s_add_u32 s26, s26, 36864
    s_add_u32 s76, s38, 0x800000
    s_addc_u32 s77, s39, 0
    s_and_b32 s77, s77, 0xffff
    s_mov_b32 s78, 0x2a8000
    s_mov_b32 s79, 0x00020000
    s_waitcnt vmcnt(11)
    ds_read_b128 v[148:151], v16 offset:0
    ds_read_b128 v[152:155], v17 offset:0
    ds_read_b128 v[156:159], v18 offset:0
    ds_read_b128 v[160:163], v19 offset:0
    s_cmp_ge_u32 s48, 1
    s_cbranch_scc0 L_rspin_45
L_rok_44:
    ds_read_b64_tr_b16 v[112:113], v20 offset:0
    ds_read_b64_tr_b16 v[114:115], v20 offset:768
    ds_read_b64_tr_b16 v[116:117], v20 offset:64
    ds_read_b64_tr_b16 v[118:119], v20 offset:832
    ds_read_b64_tr_b16 v[120:121], v20 offset:128
    ds_read_b64_tr_b16 v[122:123], v20 offset:896
    ds_read_b64_tr_b16 v[124:125], v21 offset:0
    ds_read_b64_tr_b16 v[126:127], v21 offset:768
    ds_read_b64_tr_b16 v[128:129], v21 offset:64
    ds_read_b64_tr_b16 v[130:131], v21 offset:832
    ds_read_b64_tr_b16 v[132:133], v21 offset:128
    ds_read_b64_tr_b16 v[134:135], v21 offset:896
    s_waitcnt lgkmcnt(6)
    v_mfma_f32_32x32x16_bf16 v[40:55], v[112:115], v[148:151], 0
    ds_read_b64_tr_b16 v[136:137], v22 offset:0
    ds_read_b64_tr_b16 v[138:139], v22 offset:768
    s_add_u32 m0, s18, 49152
    s_add_u32 s19, s16, s17
    buffer_load_dwordx4 v100, s[12:15], s19 offen offset:0 lds
    s_add_u32 s17, s17, 128
    s_cmp_ge_u32 s17, 1280
    s_cselect_b32 s17, 0, s17
    v_mfma_f32_32x32x16_bf16 v[56:71], v[116:119], v[148:151], 0
    ds_read_b64_tr_b16 v[140:141], v22 offset:64
    ds_read_b64_tr_b16 v[142:143], v22 offset:832
    s_waitcnt vmcnt(8)
    ds_read_b128 v[164:167], v16 offset:16384
    v_mov_b32 v13, 1
    ds_write_b32 v12, v13 offset:16
    v_mfma_f32_32x32x16_bf16 v[72:87], v[120:123], v[148:151], 0
    ds_read_b64_tr_b16 v[144:145], v22 offset:128
    ds_read_b64_tr_b16 v[146:147], v22 offset:896
    ds_read_b128 v[168:171], v17 offset:16384
    s_cmp_ge_u32 s48, 2
    s_cbranch_scc0 L_rspin_47
L_rok_46:
    ds_read_b64_tr_b16 v[208:209], v26 offset:36864
    ds_read_b64_tr_b16 v[210:211], v26 offset:38912
    ds_read_b64_tr_b16 v[212:213], v26 offset:36896
    ds_read_b64_tr_b16 v[214:215], v26 offset:38944
    v_mov_b32 v13, 2
    ds_write_b32 v12, v13
    s_mul_i32 s45, s3, 384
    v_add_u32 v26, s45, v27
    s_waitcnt lgkmcnt(14)
    v_mfma_f32_32x32x16_bf16 v[40:55], v[124:127], v[152:155], v[40:55]
    ds_read_b64_tr_b16 v[112:113], v23 offset:0
    ds_read_b64_tr_b16 v[114:115], v23 offset:768
    ds_read_b32 v31, v14
    ds_read_b128 v[172:175], v18 offset:16384
    buffer_load_dwordx4 v101, s[12:15], s19 offen offset:1024 lds
    v_mfma_f32_32x32x16_bf16 v[56:71], v[128:131], v[152:155], v[56:71]
    ds_read_b64_tr_b16 v[116:117], v23 offset:64
    ds_read_b64_tr_b16 v[118:119], v23 offset:832
    ds_read_b128 v[176:179], v19 offset:16384
    v_mfma_f32_32x32x16_bf16 v[72:87], v[132:135], v[152:155], v[72:87]
    ds_read_b64_tr_b16 v[120:121], v23 offset:128
    ds_read_b64_tr_b16 v[122:123], v23 offset:896
    v_mov_b32 v13, 4
    ds_write_b32 v12, v13
    s_waitcnt lgkmcnt(7)
    v_readfirstlane_b32 s48, v31
    s_cmp_ge_u32 s48, 3
    s_cbranch_scc0 L_rspin_49
L_rok_48:
    v_mfma_f32_32x32x16_bf16 v[40:55], v[136:139], v[156:159], v[40:55]
    ds_read_b64_tr_b16 v[124:125], v20 offset:12288
    ds_read_b64_tr_b16 v[126:127], v20 offset:13056
    v_mfma_f32_4x4x4_16b_bf16 v[88:91], v[36:37], v[136:137], 0
    buffer_load_dwordx4 v102, s[12:15], s19 offen offset:2048 lds
    ds_read_b128 v[8:11], v14 offset:32
    buffer_store_dwordx4 v[208:211], v7, s[72:75], s46 offen sc1
    s_add_u32 s46, s46, 49152
    v_mfma_f32_32x32x16_bf16 v[56:71], v[140:143], v[156:159], v[56:71]
    ds_read_b64_tr_b16 v[128:129], v20 offset:12352
    ds_read_b64_tr_b16 v[130:131], v20 offset:13120
    v_mfma_f32_4x4x4_16b_bf16 v[92:95], v[36:37], v[140:141], 0
    buffer_load_dwordx4 v103, s[12:15], s19 offen offset:3072 lds
    v_mfma_f32_32x32x16_bf16 v[72:87], v[144:147], v[156:159], v[72:87]
    ds_read_b64_tr_b16 v[132:133], v20 offset:12416
    ds_read_b64_tr_b16 v[134:135], v20 offset:13184
    v_mfma_f32_4x4x4_16b_bf16 v[96:99], v[36:37], v[144:145], 0
    s_waitcnt lgkmcnt(4)
    v_min3_u32 v8, v8, v9, v10
    v_min_u32 v8, v8, v11
    v_cmp_gt_u32 vcc, 1, v8
    s_cbranch_vccz L_bc_50
    s_mov_b32 s54, 0
L_bspin_51:
    ds_read_b128 v[8:11], v14 offset:32
    s_add_u32 s54, s54, 1
    s_cmp_gt_u32 s54, 0x100000
    s_waitcnt lgkmcnt(0)
    v_min3_u32 v8, v8, v9, v10
    v_min_u32 v8, v8, v11
    s_cbranch_scc1 L_bok_52
    v_cmp_gt_u32 vcc, 1, v8
    s_cbranch_vccnz L_bspin_51
L_bok_52:
L_bc_50:
    ds_read_b64_tr_b16 v[224:225], v216 offset:0
    ds_read_b64_tr_b16 v[226:227], v217 offset:512
    ds_read_b64_tr_b16 v[228:229], v218 offset:1024
    ds_read_b64_tr_b16 v[230:231], v219 offset:1536
    ds_read_b64_tr_b16 v[232:233], v216 offset:2048
    ds_read_b64_tr_b16 v[234:235], v217 offset:2560
    ds_read_b64_tr_b16 v[236:237], v218 offset:3072
    ds_read_b64_tr_b16 v[238:239], v219 offset:3584
    v_mov_b32 v13, 2
    ds_write_b32 v12, v13 offset:16
    v_mfma_f32_32x32x16_bf16 v[40:55], v[112:115], v[160:163], v[40:55]
    ds_read_b64_tr_b16 v[136:137], v21 offset:12288
    ds_read_b64_tr_b16 v[138:139], v21 offset:13056
    v_mfma_f32_4x4x4_16b_bf16 v[88:91], v[36:37], v[114:115], v[88:91]
    buffer_store_dwordx4 v[212:215], v7, s[72:75], s46 offen sc1
    v_mfma_f32_32x32x16_bf16 v[56:71], v[116:119], v[160:163], v[56:71]
    ds_read_b64_tr_b16 v[140:141], v21 offset:12352
    ds_read_b64_tr_b16 v[142:143], v21 offset:13120
    v_mfma_f32_4x4x4_16b_bf16 v[92:95], v[36:37], v[118:119], v[92:95]
    v_mfma_f32_32x32x16_bf16 v[72:87], v[120:123], v[160:163], v[72:87]
    ds_read_b64_tr_b16 v[144:145], v21 offset:12416
    ds_read_b64_tr_b16 v[146:147], v21 offset:13184
    v_mfma_f32_4x4x4_16b_bf16 v[96:99], v[36:37], v[122:123], v[96:99]
    s_waitcnt lgkmcnt(14)
    v_mfma_f32_32x32x16_bf16 v[40:55], v[124:127], v[164:167], v[40:55]
    ds_read_b64_tr_b16 v[112:113], v22 offset:12288
    ds_read_b64_tr_b16 v[114:115], v22 offset:13056
    s_waitcnt lgkmcnt(9)
    s_mov_b32 vcc_lo, 0x55555555
    s_mov_b32 vcc_hi, 0x55555555
    v_cndmask_b32_dpp v240, v228, v224, vcc quad_perm:[1,0,3,2] row_mask:0xf bank_mask:0xf
    v_cndmask_b32_dpp v241, v229, v225, vcc quad_perm:[1,0,3,2] row_mask:0xf bank_mask:0xf
    v_cndmask_b32_dpp v242, v230, v226, vcc quad_perm:[1,0,3,2] row_mask:0xf bank_mask:0xf
    v_cndmask_b32_dpp v243, v231, v227, vcc quad_perm:[1,0,3,2] row_mask:0xf bank_mask:0xf
    ds_read_b128 v[8:11], v14 offset:32
    v_mfma_f32_32x32x16_bf16 v[56:71], v[128:131], v[164:167], v[56:71]
    ds_read_b64_tr_b16 v[116:117], v22 offset:12352
    ds_read_b64_tr_b16 v[118:119], v22 offset:13120
    s_waitcnt vmcnt(9)
    ds_read_b128 v[148:151], v16 offset:32768
    s_mov_b32 vcc_lo, 0x55555555
    s_mov_b32 vcc_hi, 0x55555555
    v_cndmask_b32_dpp v248, v236, v232, vcc quad_perm:[1,0,3,2] row_mask:0xf bank_mask:0xf
    v_cndmask_b32_dpp v249, v237, v233, vcc quad_perm:[1,0,3,2] row_mask:0xf bank_mask:0xf
    v_cndmask_b32_dpp v250, v238, v234, vcc quad_perm:[1,0,3,2] row_mask:0xf bank_mask:0xf
    v_cndmask_b32_dpp v251, v239, v235, vcc quad_perm:[1,0,3,2] row_mask:0xf bank_mask:0xf
    v_mfma_f32_32x32x16_bf16 v[72:87], v[132:135], v[164:167], v[72:87]
    ds_read_b64_tr_b16 v[120:121], v22 offset:12416
    ds_read_b64_tr_b16 v[122:123], v22 offset:13184
    ds_read_b128 v[152:155], v17 offset:32768
    s_waitcnt lgkmcnt(6)
    v_min3_u32 v8, v8, v9, v10
    v_min_u32 v8, v8, v11
    v_cmp_gt_u32 vcc, 2, v8
    s_cbranch_vccz L_bc_53
    s_mov_b32 s54, 0
L_bspin_54:
    ds_read_b128 v[8:11], v14 offset:32
    s_add_u32 s54, s54, 1
    s_cmp_gt_u32 s54, 0x100000
    s_waitcnt lgkmcnt(0)
    v_min3_u32 v8, v8, v9, v10
    v_min_u32 v8, v8, v11
    s_cbranch_scc1 L_bok_55
    v_cmp_gt_u32 vcc, 2, v8
    s_cbranch_vccnz L_bspin_54
L_bok_55:
L_bc_53:
    s_add_u32 m0, s18, 65536
    s_add_u32 s19, s16, s17
    buffer_load_dwordx4 v100, s[12:15], s19 offen offset:0 lds
    s_add_u32 s17, s17, 128
    s_cmp_ge_u32 s17, 1280
    s_cselect_b32 s17, 0, s17
    v_mfma_f32_32x32x16_bf16 v[40:55], v[136:139], v[168:171], v[40:55]
    ds_read_b64_tr_b16 v[124:125], v23 offset:12288
    ds_read_b64_tr_b16 v[126:127], v23 offset:13056
    ds_read_b32 v31, v14
    ds_read_b128 v[156:159], v18 offset:32768
    buffer_load_dwordx4 v101, s[12:15], s19 offen offset:1024 lds
    v_mfma_f32_32x32x16_bf16 v[56:71], v[140:143], v[168:171], v[56:71]
    ds_read_b64_tr_b16 v[128:129], v23 offset:12352
    ds_read_b64_tr_b16 v[130:131], v23 offset:13120
    ds_read_b128 v[160:163], v19 offset:32768
    s_mov_b32 vcc_lo, 0xaaaaaaaa
    s_mov_b32 vcc_hi, 0xaaaaaaaa
    v_cndmask_b32_dpp v244, v224, v228, vcc quad_perm:[1,0,3,2] row_mask:0xf bank_mask:0xf
    v_cndmask_b32_dpp v245, v225, v229, vcc quad_perm:[1,0,3,2] row_mask:0xf bank_mask:0xf
    v_cndmask_b32_dpp v246, v226, v230, vcc quad_perm:[1,0,3,2] row_mask:0xf bank_mask:0xf
    v_cndmask_b32_dpp v247, v227, v231, vcc quad_perm:[1,0,3,2] row_mask:0xf bank_mask:0xf
    s_mov_b32 vcc_lo, 0xaaaaaaaa
    s_mov_b32 vcc_hi, 0xaaaaaaaa
    v_cndmask_b32_dpp v252, v232, v236, vcc quad_perm:[1,0,3,2] row_mask:0xf bank_mask:0xf
    v_cndmask_b32_dpp v253, v233, v237, vcc quad_perm:[1,0,3,2] row_mask:0xf bank_mask:0xf
    v_cndmask_b32_dpp v254, v234, v238, vcc quad_perm:[1,0,3,2] row_mask:0xf bank_mask:0xf
    v_cndmask_b32_dpp v255, v235, v239, vcc quad_perm:[1,0,3,2] row_mask:0xf bank_mask:0xf
    v_mfma_f32_32x32x16_bf16 v[72:87], v[144:147], v[168:171], v[72:87]
    ds_read_b64_tr_b16 v[132:133], v23 offset:12416
    ds_read_b64_tr_b16 v[134:135], v23 offset:13184
    v_mov_b32 v13, 6
    ds_write_b32 v12, v13
    s_waitcnt lgkmcnt(7)
    v_readfirstlane_b32 s48, v31
    s_cmp_ge_u32 s48, 4
    s_cbranch_scc0 L_rspin_57
L_rok_56:
    buffer_load_dwordx4 v102, s[12:15], s19 offen offset:2048 lds
    v_mfma_f32_32x32x16_bf16 v[40:55], v[112:115], v[172:175], v[40:55]
    ds_read_b64_tr_b16 v[136:137], v20 offset:24576
    ds_read_b64_tr_b16 v[138:139], v20 offset:25344
    v_mfma_f32_4x4x4_16b_bf16 v[88:91], v[36:37], v[112:113], v[88:91]
    buffer_load_dwordx4 v103, s[12:15], s19 offen offset:3072 lds
    v_mfma_f32_32x32x16_bf16 v[56:71], v[116:119], v[172:175], v[56:71]
    ds_read_b64_tr_b16 v[140:141], v20 offset:24640
    ds_read_b64_tr_b16 v[142:143], v20 offset:25408
    v_mfma_f32_4x4x4_16b_bf16 v[92:95], v[36:37], v[116:117], v[92:95]
    s_waitcnt lgkmcnt(7)
    s_add_u32 m0, s18, 81920
    s_add_u32 s19, s16, s17
    buffer_load_dwordx4 v100, s[12:15], s19 offen offset:0 lds
    s_add_u32 s17, s17, 128
    s_cmp_ge_u32 s17, 1280
    s_cselect_b32 s17, 0, s17
    global_load_dwordx2 v[4:5], v6, s[36:37] sc1
    v_mfma_f32_32x32x16_bf16 v[72:87], v[120:123], v[172:175], v[72:87]
    ds_read_b64_tr_b16 v[144:145], v20 offset:24704
    ds_read_b64_tr_b16 v[146:147], v20 offset:25472
    v_mfma_f32_4x4x4_16b_bf16 v[96:99], v[36:37], v[120:121], v[96:99]
    s_mov_b32 vcc_lo, 0x33333333
    s_mov_b32 vcc_hi, 0x33333333
    v_cndmask_b32_dpp v224, v248, v240, vcc quad_perm:[2,3,0,1] row_mask:0xf bank_mask:0xf
    v_cndmask_b32_dpp v225, v249, v241, vcc quad_perm:[2,3,0,1] row_mask:0xf bank_mask:0xf
    v_cndmask_b32_dpp v226, v250, v242, vcc quad_perm:[2,3,0,1] row_mask:0xf bank_mask:0xf
    v_cndmask_b32_dpp v227, v251, v243, vcc quad_perm:[2,3,0,1] row_mask:0xf bank_mask:0xf
    buffer_load_dwordx4 v101, s[12:15], s19 offen offset:1024 lds
    s_waitcnt lgkmcnt(7)
    v_mfma_f32_32x32x16_bf16 v[40:55], v[124:127], v[176:179], v[40:55]
    ds_read_b64_tr_b16 v[112:113], v21 offset:24576
    ds_read_b64_tr_b16 v[114:115], v21 offset:25344
    v_mfma_f32_4x4x4_16b_bf16 v[88:91], v[36:37], v[126:127], v[88:91]
    s_mov_b32 vcc_lo, 0x33333333
    s_mov_b32 vcc_hi, 0x33333333
    v_cndmask_b32_dpp v228, v252, v244, vcc quad_perm:[2,3,0,1] row_mask:0xf bank_mask:0xf
    v_cndmask_b32_dpp v229, v253, v245, vcc quad_perm:[2,3,0,1] row_mask:0xf bank_mask:0xf
    v_cndmask_b32_dpp v230, v254, v246, vcc quad_perm:[2,3,0,1] row_mask:0xf bank_mask:0xf
    v_cndmask_b32_dpp v231, v255, v247, vcc quad_perm:[2,3,0,1] row_mask:0xf bank_mask:0xf
    s_mov_b32 vcc_lo, 0xcccccccc
    s_mov_b32 vcc_hi, 0xcccccccc
    v_cndmask_b32_dpp v232, v240, v248, vcc quad_perm:[2,3,0,1] row_mask:0xf bank_mask:0xf
    v_cndmask_b32_dpp v233, v241, v249, vcc quad_perm:[2,3,0,1] row_mask:0xf bank_mask:0xf
    v_cndmask_b32_dpp v234, v242, v250, vcc quad_perm:[2,3,0,1] row_mask:0xf bank_mask:0xf
    v_cndmask_b32_dpp v235, v243, v251, vcc quad_perm:[2,3,0,1] row_mask:0xf bank_mask:0xf
    v_mfma_f32_32x32x16_bf16 v[56:71], v[128:131], v[176:179], v[56:71]
    ds_read_b64_tr_b16 v[116:117], v21 offset:24640
    ds_read_b64_tr_b16 v[118:119], v21 offset:25408
    v_mfma_f32_4x4x4_16b_bf16 v[92:95], v[36:37], v[130:131], v[92:95]
    s_mov_b32 vcc_lo, 0xcccccccc
    s_mov_b32 vcc_hi, 0xcccccccc
    v_cndmask_b32_dpp v236, v244, v252, vcc quad_perm:[2,3,0,1] row_mask:0xf bank_mask:0xf
    v_cndmask_b32_dpp v237, v245, v253, vcc quad_perm:[2,3,0,1] row_mask:0xf bank_mask:0xf
    v_cndmask_b32_dpp v238, v246, v254, vcc quad_perm:[2,3,0,1] row_mask:0xf bank_mask:0xf
    v_cndmask_b32_dpp v239, v247, v255, vcc quad_perm:[2,3,0,1] row_mask:0xf bank_mask:0xf
    buffer_load_dwordx4 v102, s[12:15], s19 offen offset:2048 lds
    v_mfma_f32_32x32x16_bf16 v[72:87], v[132:135], v[176:179], v[72:87]
    ds_read_b64_tr_b16 v[120:121], v21 offset:24704
    ds_read_b64_tr_b16 v[122:123], v21 offset:25472
    v_mfma_f32_4x4x4_16b_bf16 v[96:99], v[36:37], v[134:135], v[96:99]
    buffer_load_dwordx4 v103, s[12:15], s19 offen offset:3072 lds
    s_waitcnt lgkmcnt(6)
    v_mfma_f32_32x32x16_bf16 v[40:55], v[136:139], v[148:151], v[40:55]
    ds_read_b64_tr_b16 v[124:125], v22 offset:24576
    ds_read_b64_tr_b16 v[126:127], v22 offset:25344
    buffer_store_dwordx4 v[224:227], v220, s[76:79], s55 offen sc1
    s_add_u32 s55, s55, 4352
    v_mfma_f32_32x32x16_bf16 v[56:71], v[140:143], v[148:151], v[56:71]
    ds_read_b64_tr_b16 v[128:129], v22 offset:24640
    ds_read_b64_tr_b16 v[130:131], v22 offset:25408
    s_waitcnt vmcnt(11)
    ds_read_b128 v[164:167], v16 offset:0
    v_mfma_f32_32x32x16_bf16 v[72:87], v[144:147], v[148:151], v[72:87]
    ds_read_b64_tr_b16 v[132:133], v22 offset:24704
    ds_read_b64_tr_b16 v[134:135], v22 offset:25472
    ds_read_b128 v[168:171], v17 offset:0
    s_waitcnt lgkmcnt(8)
    v_mfma_f32_32x32x16_bf16 v[40:55], v[112:115], v[152:155], v[40:55]
    ds_read_b64_tr_b16 v[136:137], v23 offset:24576
    ds_read_b64_tr_b16 v[138:139], v23 offset:25344
    ds_read_b32 v31, v14
    ds_read_b128 v[172:175], v18 offset:0
    v_mfma_f32_32x32x16_bf16 v[56:71], v[116:119], v[152:155], v[56:71]
    ds_read_b64_tr_b16 v[140:141], v23 offset:24640
    ds_read_b64_tr_b16 v[142:143], v23 offset:25408
    ds_read_b128 v[176:179], v19 offset:0
    v_mfma_f32_32x32x16_bf16 v[72:87], v[120:123], v[152:155], v[72:87]
    ds_read_b64_tr_b16 v[144:145], v23 offset:24704
    ds_read_b64_tr_b16 v[146:147], v23 offset:25472
    v_mov_b32 v13, 8
    ds_write_b32 v12, v13
    s_waitcnt lgkmcnt(7)
    v_readfirstlane_b32 s48, v31
    s_cmp_ge_u32 s48, 5
    s_cbranch_scc0 L_rspin_59
L_rok_58:
    v_mfma_f32_32x32x16_bf16 v[40:55], v[124:127], v[156:159], v[40:55]
    ds_read_b64_tr_b16 v[112:113], v20 offset:36864
    ds_read_b64_tr_b16 v[114:115], v20 offset:37632
    v_mfma_f32_4x4x4_16b_bf16 v[88:91], v[36:37], v[124:125], v[88:91]
    v_mfma_f32_32x32x16_bf16 v[56:71], v[128:131], v[156:159], v[56:71]
    ds_read_b64_tr_b16 v[116:117], v20 offset:36928
    ds_read_b64_tr_b16 v[118:119], v20 offset:37696
    v_mfma_f32_4x4x4_16b_bf16 v[92:95], v[36:37], v[128:129], v[92:95]
    s_waitcnt lgkmcnt(7)
    s_add_u32 m0, s18, 49152
    s_add_u32 s19, s16, s17
    buffer_load_dwordx4 v100, s[12:15], s19 offen offset:0 lds
    s_add_u32 s17, s17, 128
    s_cmp_ge_u32 s17, 1280
    s_cselect_b32 s17, 0, s17
    buffer_store_dwordx4 v[228:231], v220, s[76:79], s55 offen sc1
    s_add_u32 s55, s55, 4352
    v_mfma_f32_32x32x16_bf16 v[72:87], v[132:135], v[156:159], v[72:87]
    ds_read_b64_tr_b16 v[120:121], v20 offset:36992
    ds_read_b64_tr_b16 v[122:123], v20 offset:37760
    v_mfma_f32_4x4x4_16b_bf16 v[96:99], v[36:37], v[132:133], v[96:99]
    buffer_load_dwordx4 v101, s[12:15], s19 offen offset:1024 lds
    buffer_store_dwordx4 v[232:235], v220, s[76:79], s55 offen sc1
    s_add_u32 s55, s55, 4352
    s_waitcnt lgkmcnt(7)
    v_mfma_f32_32x32x16_bf16 v[40:55], v[136:139], v[160:163], v[40:55]
    ds_read_b64_tr_b16 v[124:125], v21 offset:36864
    ds_read_b64_tr_b16 v[126:127], v21 offset:37632
    v_mfma_f32_4x4x4_16b_bf16 v[88:91], v[36:37], v[138:139], v[88:91]
    v_mfma_f32_32x32x16_bf16 v[56:71], v[140:143], v[160:163], v[56:71]
    ds_read_b64_tr_b16 v[128:129], v21 offset:36928
    ds_read_b64_tr_b16 v[130:131], v21 offset:37696
    v_mfma_f32_4x4x4_16b_bf16 v[92:95], v[36:37], v[142:143], v[92:95]
    buffer_load_dwordx4 v102, s[12:15], s19 offen offset:2048 lds
    v_mfma_f32_32x32x16_bf16 v[72:87], v[144:147], v[160:163], v[72:87]
    ds_read_b64_tr_b16 v[132:133], v21 offset:36992
    ds_read_b64_tr_b16 v[134:135], v21 offset:37760
    v_mfma_f32_4x4x4_16b_bf16 v[96:99], v[36:37], v[146:147], v[96:99]
    buffer_load_dwordx4 v103, s[12:15], s19 offen offset:3072 lds
    buffer_store_dwordx4 v[236:239], v220, s[76:79], s55 offen sc1
    s_waitcnt lgkmcnt(6)
    v_mfma_f32_32x32x16_bf16 v[40:55], v[112:115], v[164:167], v[40:55]
    ds_read_b64_tr_b16 v[136:137], v22 offset:36864
    ds_read_b64_tr_b16 v[138:139], v22 offset:37632
    s_waitcnt vmcnt(11)
    v_cmp_ne_u32 vcc, 0, v4
    s_cbranch_vccnz L_tagok_60
    s_mov_b32 s54, 0
L_tagspin_61:
    s_sleep 2
    global_load_dwordx2 v[4:5], v6, s[36:37] sc1
    s_add_u32 s54, s54, 1
    s_cmp_gt_u32 s54, 0x10000
    s_waitcnt vmcnt(0)
    s_cbranch_scc1 L_tagok_60
    v_cmp_ne_u32 vcc, 0, v4
    s_cbranch_vccz L_tagspin_61
L_tagok_60:
    s_mov_b64 exec, 1
    buffer_store_dwordx2 v[4:5], v6, s[64:67], s51 offen offset:0 sc1
    s_mov_b64 exec, -1
    v_mfma_f32_32x32x16_bf16 v[56:71], v[116:119], v[164:167], v[56:71]
    ds_read_b64_tr_b16 v[140:141], v22 offset:36928
    ds_read_b64_tr_b16 v[142:143], v22 offset:37696
    ds_read_b128 v[148:151], v16 offset:16384
    v_mfma_f32_32x32x16_bf16 v[72:87], v[120:123], v[164:167], v[72:87]
    ds_read_b64_tr_b16 v[144:145], v22 offset:36992
    ds_read_b64_tr_b16 v[146:147], v22 offset:37760
    ds_read_b128 v[152:155], v17 offset:16384
    s_waitcnt lgkmcnt(8)
    v_mfma_f32_32x32x16_bf16 v[40:55], v[124:127], v[168:171], v[40:55]
    ds_read_b64_tr_b16 v[112:113], v23 offset:36864
    ds_read_b64_tr_b16 v[114:115], v23 offset:37632
    ds_read_b32 v31, v14
    ds_read_b128 v[156:159], v18 offset:16384
    v_mfma_f32_32x32x16_bf16 v[56:71], v[128:131], v[168:171], v[56:71]
    ds_read_b64_tr_b16 v[116:117], v23 offset:36928
    ds_read_b64_tr_b16 v[118:119], v23 offset:37696
    ds_read_b128 v[160:163], v19 offset:16384
    v_mfma_f32_32x32x16_bf16 v[72:87], v[132:135], v[168:171], v[72:87]
    ds_read_b64_tr_b16 v[120:121], v23 offset:36992
    ds_read_b64_tr_b16 v[122:123], v23 offset:37760
    v_mov_b32 v13, 10
    ds_write_b32 v12, v13
    s_waitcnt lgkmcnt(7)
    v_readfirstlane_b32 s48, v31
    s_cmp_ge_u32 s48, 6
    s_cbranch_scc0 L_rspin_63
L_rok_62:
    v_mfma_f32_32x32x16_bf16 v[40:55], v[136:139], v[172:175], v[40:55]
    ds_read_b64_tr_b16 v[124:125], v20 offset:0
    ds_read_b64_tr_b16 v[126:127], v20 offset:768
    v_mfma_f32_4x4x4_16b_bf16 v[88:91], v[36:37], v[136:137], v[88:91]
    v_mfma_f32_32x32x16_bf16 v[56:71], v[140:143], v[172:175], v[56:71]
    ds_read_b64_tr_b16 v[128:129], v20 offset:64
    ds_read_b64_tr_b16 v[130:131], v20 offset:832
    v_mfma_f32_4x4x4_16b_bf16 v[92:95], v[36:37], v[140:141], v[92:95]
    s_waitcnt lgkmcnt(7)
    s_add_u32 m0, s18, 65536
    s_add_u32 s19, s16, s17
    buffer_load_dwordx4 v100, s[12:15], s19 offen offset:0 lds
    s_add_u32 s17, s17, 128
    s_cmp_ge_u32 s17, 1280
    s_cselect_b32 s17, 0, s17
    v_mfma_f32_32x32x16_bf16 v[72:87], v[144:147], v[172:175], v[72:87]
    ds_read_b64_tr_b16 v[132:133], v20 offset:128
    ds_read_b64_tr_b16 v[134:135], v20 offset:896
    v_mfma_f32_4x4x4_16b_bf16 v[96:99], v[36:37], v[144:145], v[96:99]
    buffer_load_dwordx4 v101, s[12:15], s19 offen offset:1024 lds
    s_waitcnt lgkmcnt(7)
    v_mfma_f32_32x32x16_bf16 v[40:55], v[112:115], v[176:179], v[40:55]
    ds_read_b64_tr_b16 v[136:137], v21 offset:0
    ds_read_b64_tr_b16 v[138:139], v21 offset:768
    v_mfma_f32_4x4x4_16b_bf16 v[88:91], v[36:37], v[114:115], v[88:91]
    v_mfma_f32_32x32x16_bf16 v[56:71], v[116:119], v[176:179], v[56:71]
    ds_read_b64_tr_b16 v[140:141], v21 offset:64
    ds_read_b64_tr_b16 v[142:143], v21 offset:832
    v_mfma_f32_4x4x4_16b_bf16 v[92:95], v[36:37], v[118:119], v[92:95]
    buffer_load_dwordx4 v102, s[12:15], s19 offen offset:2048 lds
    v_mfma_f32_32x32x16_bf16 v[72:87], v[120:123], v[176:179], v[72:87]
    ds_read_b64_tr_b16 v[144:145], v21 offset:128
    ds_read_b64_tr_b16 v[146:147], v21 offset:896
    v_mfma_f32_4x4x4_16b_bf16 v[96:99], v[36:37], v[122:123], v[96:99]
    buffer_load_dwordx4 v103, s[12:15], s19 offen offset:3072 lds
    s_waitcnt lgkmcnt(6)
    v_mfma_f32_32x32x16_bf16 v[40:55], v[124:127], v[148:151], v[40:55]
    ds_read_b64_tr_b16 v[112:113], v22 offset:0
    ds_read_b64_tr_b16 v[114:115], v22 offset:768
    v_mfma_f32_32x32x16_bf16 v[56:71], v[128:131], v[148:151], v[56:71]
    ds_read_b64_tr_b16 v[116:117], v22 offset:64
    ds_read_b64_tr_b16 v[118:119], v22 offset:832
    s_waitcnt vmcnt(13)
    ds_read_b128 v[164:167], v16 offset:32768
    v_mfma_f32_32x32x16_bf16 v[72:87], v[132:135], v[148:151], v[72:87]
    ds_read_b64_tr_b16 v[120:121], v22 offset:128
    ds_read_b64_tr_b16 v[122:123], v22 offset:896
    ds_read_b128 v[168:171], v17 offset:32768
    s_waitcnt lgkmcnt(8)
    v_mfma_f32_32x32x16_bf16 v[40:55], v[136:139], v[152:155], v[40:55]
    ds_read_b64_tr_b16 v[124:125], v23 offset:0
    ds_read_b64_tr_b16 v[126:127], v23 offset:768
    ds_read_b32 v31, v14
    ds_read_b128 v[172:175], v18 offset:32768
    v_mfma_f32_32x32x16_bf16 v[56:71], v[140:143], v[152:155], v[56:71]
    ds_read_b64_tr_b16 v[128:129], v23 offset:64
    ds_read_b64_tr_b16 v[130:131], v23 offset:832
    ds_read_b128 v[176:179], v19 offset:32768
    v_mfma_f32_32x32x16_bf16 v[72:87], v[144:147], v[152:155], v[72:87]
    ds_read_b64_tr_b16 v[132:133], v23 offset:128
    ds_read_b64_tr_b16 v[134:135], v23 offset:896
    v_mov_b32 v13, 12
    ds_write_b32 v12, v13
    s_waitcnt lgkmcnt(7)
    v_readfirstlane_b32 s48, v31
    s_cmp_ge_u32 s48, 7
    s_cbranch_scc0 L_rspin_65
L_rok_64:
    v_mfma_f32_32x32x16_bf16 v[40:55], v[112:115], v[156:159], v[40:55]
    ds_read_b64_tr_b16 v[136:137], v20 offset:12288
    ds_read_b64_tr_b16 v[138:139], v20 offset:13056
    v_mfma_f32_4x4x4_16b_bf16 v[88:91], v[36:37], v[112:113], v[88:91]
    v_mfma_f32_32x32x16_bf16 v[56:71], v[116:119], v[156:159], v[56:71]
    ds_read_b64_tr_b16 v[140:141], v20 offset:12352
    ds_read_b64_tr_b16 v[142:143], v20 offset:13120
    v_mfma_f32_4x4x4_16b_bf16 v[92:95], v[36:37], v[116:117], v[92:95]
    s_waitcnt lgkmcnt(7)
    s_add_u32 m0, s18, 81920
    s_add_u32 s19, s16, s17
    buffer_load_dwordx4 v100, s[12:15], s19 offen offset:0 lds
    s_add_u32 s17, s17, 128
    s_cmp_ge_u32 s17, 1280
    s_cselect_b32 s17, 0, s17
    v_mfma_f32_32x32x16_bf16 v[72:87], v[120:123], v[156:159], v[72:87]
    ds_read_b64_tr_b16 v[144:145], v20 offset:12416
    ds_read_b64_tr_b16 v[146:147], v20 offset:13184
    v_mfma_f32_4x4x4_16b_bf16 v[96:99], v[36:37], v[120:121], v[96:99]
    buffer_load_dwordx4 v101, s[12:15], s19 offen offset:1024 lds
    s_waitcnt lgkmcnt(7)
    v_mfma_f32_32x32x16_bf16 v[40:55], v[124:127], v[160:163], v[40:55]
    ds_read_b64_tr_b16 v[112:113], v21 offset:12288
    ds_read_b64_tr_b16 v[114:115], v21 offset:13056
    v_mfma_f32_4x4x4_16b_bf16 v[88:91], v[36:37], v[126:127], v[88:91]
    v_mfma_f32_32x32x16_bf16 v[56:71], v[128:131], v[160:163], v[56:71]
    ds_read_b64_tr_b16 v[116:117], v21 offset:12352
    ds_read_b64_tr_b16 v[118:119], v21 offset:13120
    v_mfma_f32_4x4x4_16b_bf16 v[92:95], v[36:37], v[130:131], v[92:95]
    buffer_load_dwordx4 v102, s[12:15], s19 offen offset:2048 lds
    v_mfma_f32_32x32x16_bf16 v[72:87], v[132:135], v[160:163], v[72:87]
    ds_read_b64_tr_b16 v[120:121], v21 offset:12416
    ds_read_b64_tr_b16 v[122:123], v21 offset:13184
    v_mfma_f32_4x4x4_16b_bf16 v[96:99], v[36:37], v[134:135], v[96:99]
    buffer_load_dwordx4 v103, s[12:15], s19 offen offset:3072 lds
    s_waitcnt lgkmcnt(6)
    v_mfma_f32_32x32x16_bf16 v[40:55], v[136:139], v[164:167], v[40:55]
    ds_read_b64_tr_b16 v[124:125], v22 offset:12288
    ds_read_b64_tr_b16 v[126:127], v22 offset:13056
    v_mfma_f32_32x32x16_bf16 v[56:71], v[140:143], v[164:167], v[56:71]
    ds_read_b64_tr_b16 v[128:129], v22 offset:12352
    ds_read_b64_tr_b16 v[130:131], v22 offset:13120
    s_waitcnt vmcnt(9)
    s_mov_b64 exec, 1
    buffer_store_dwordx2 v[4:5], v6, s[64:67], s26 offen offset:0 sc1
    s_mov_b64 exec, -1
    s_mov_b32 s76, s34
    s_and_b32 s77, s35, 0xffff
    s_mov_b32 s78, 0x280000
    s_mov_b32 s79, 0x00020000
    ds_read_b128 v[148:151], v16 offset:0
    v_mfma_f32_32x32x16_bf16 v[72:87], v[144:147], v[164:167], v[72:87]
    ds_read_b64_tr_b16 v[132:133], v22 offset:12416
    ds_read_b64_tr_b16 v[134:135], v22 offset:13184
    ds_read_b128 v[152:155], v17 offset:0
    s_waitcnt lgkmcnt(8)
    v_mfma_f32_32x32x16_bf16 v[40:55], v[112:115], v[168:171], v[40:55]
    ds_read_b64_tr_b16 v[136:137], v23 offset:12288
    ds_read_b64_tr_b16 v[138:139], v23 offset:13056
    ds_read_b32 v31, v14
    ds_read_b128 v[156:159], v18 offset:0
    v_mfma_f32_32x32x16_bf16 v[56:71], v[116:119], v[168:171], v[56:71]
    ds_read_b64_tr_b16 v[140:141], v23 offset:12352
    ds_read_b64_tr_b16 v[142:143], v23 offset:13120
    ds_read_b128 v[160:163], v19 offset:0
    v_mfma_f32_32x32x16_bf16 v[72:87], v[120:123], v[168:171], v[72:87]
    ds_read_b64_tr_b16 v[144:145], v23 offset:12416
    ds_read_b64_tr_b16 v[146:147], v23 offset:13184
    v_mov_b32 v13, 14
    ds_write_b32 v12, v13
    s_waitcnt lgkmcnt(7)
    v_readfirstlane_b32 s48, v31
    s_cmp_ge_u32 s48, 8
    s_cbranch_scc0 L_rspin_67
L_rok_66:
    v_mfma_f32_32x32x16_bf16 v[40:55], v[124:127], v[172:175], v[40:55]
    ds_read_b64_tr_b16 v[112:113], v20 offset:24576
    ds_read_b64_tr_b16 v[114:115], v20 offset:25344
    v_mfma_f32_4x4x4_16b_bf16 v[88:91], v[36:37], v[124:125], v[88:91]
    v_mfma_f32_32x32x16_bf16 v[56:71], v[128:131], v[172:175], v[56:71]
    ds_read_b64_tr_b16 v[116:117], v20 offset:24640
    ds_read_b64_tr_b16 v[118:119], v20 offset:25408
    v_mfma_f32_4x4x4_16b_bf16 v[92:95], v[36:37], v[128:129], v[92:95]
    s_waitcnt lgkmcnt(7)
    s_add_u32 m0, s18, 49152
    s_add_u32 s19, s16, s17
    buffer_load_dwordx4 v100, s[12:15], s19 offen offset:0 lds
    s_add_u32 s17, s17, 128
    s_cmp_ge_u32 s17, 1280
    s_cselect_b32 s17, 0, s17
    v_mfma_f32_32x32x16_bf16 v[72:87], v[132:135], v[172:175], v[72:87]
    ds_read_b64_tr_b16 v[120:121], v20 offset:24704
    ds_read_b64_tr_b16 v[122:123], v20 offset:25472
    v_mfma_f32_4x4x4_16b_bf16 v[96:99], v[36:37], v[132:133], v[96:99]
    buffer_load_dwordx4 v101, s[12:15], s19 offen offset:1024 lds
    s_waitcnt lgkmcnt(7)
    v_mfma_f32_32x32x16_bf16 v[40:55], v[136:139], v[176:179], v[40:55]
    ds_read_b64_tr_b16 v[124:125], v21 offset:24576
    ds_read_b64_tr_b16 v[126:127], v21 offset:25344
    v_mfma_f32_4x4x4_16b_bf16 v[88:91], v[36:37], v[138:139], v[88:91]
    v_mfma_f32_32x32x16_bf16 v[56:71], v[140:143], v[176:179], v[56:71]
    ds_read_b64_tr_b16 v[128:129], v21 offset:24640
    ds_read_b64_tr_b16 v[130:131], v21 offset:25408
    v_mfma_f32_4x4x4_16b_bf16 v[92:95], v[36:37], v[142:143], v[92:95]
    buffer_load_dwordx4 v102, s[12:15], s19 offen offset:2048 lds
    v_mfma_f32_32x32x16_bf16 v[72:87], v[144:147], v[176:179], v[72:87]
    ds_read_b64_tr_b16 v[132:133], v21 offset:24704
    ds_read_b64_tr_b16 v[134:135], v21 offset:25472
    v_mfma_f32_4x4x4_16b_bf16 v[96:99], v[36:37], v[146:147], v[96:99]
    buffer_load_dwordx4 v103, s[12:15], s19 offen offset:3072 lds
    s_waitcnt lgkmcnt(6)
    v_mfma_f32_32x32x16_bf16 v[40:55], v[112:115], v[148:151], v[40:55]
    ds_read_b64_tr_b16 v[136:137], v22 offset:24576
    ds_read_b64_tr_b16 v[138:139], v22 offset:25344
    v_mfma_f32_32x32x16_bf16 v[56:71], v[116:119], v[148:151], v[56:71]
    ds_read_b64_tr_b16 v[140:141], v22 offset:24640
    ds_read_b64_tr_b16 v[142:143], v22 offset:25408
    s_waitcnt vmcnt(9)
    ds_read_b128 v[164:167], v16 offset:16384
    v_mfma_f32_32x32x16_bf16 v[72:87], v[120:123], v[148:151], v[72:87]
    ds_read_b64_tr_b16 v[144:145], v22 offset:24704
    ds_read_b64_tr_b16 v[146:147], v22 offset:25472
    ds_read_b128 v[168:171], v17 offset:16384
    s_waitcnt lgkmcnt(8)
    v_mfma_f32_32x32x16_bf16 v[40:55], v[124:127], v[152:155], v[40:55]
    ds_read_b64_tr_b16 v[112:113], v23 offset:24576
    ds_read_b64_tr_b16 v[114:115], v23 offset:25344
    ds_read_b32 v31, v14
    ds_read_b128 v[172:175], v18 offset:16384
    v_mfma_f32_32x32x16_bf16 v[56:71], v[128:131], v[152:155], v[56:71]
    ds_read_b64_tr_b16 v[116:117], v23 offset:24640
    ds_read_b64_tr_b16 v[118:119], v23 offset:25408
    ds_read_b128 v[176:179], v19 offset:16384
    v_mov_b32 v13, 15
    ds_write_b32 v12, v13
    v_mfma_f32_32x32x16_bf16 v[72:87], v[132:135], v[152:155], v[72:87]
    ds_read_b64_tr_b16 v[120:121], v23 offset:24704
    ds_read_b64_tr_b16 v[122:123], v23 offset:25472
    v_mov_b32 v13, 16
    ds_write_b32 v12, v13
    s_waitcnt lgkmcnt(8)
    v_readfirstlane_b32 s48, v31
    s_cmp_ge_u32 s48, 9
    s_cbranch_scc0 L_rspin_69
L_rok_68:
    v_mfma_f32_32x32x16_bf16 v[40:55], v[136:139], v[156:159], v[40:55]
    ds_read_b64_tr_b16 v[124:125], v20 offset:36864
    ds_read_b64_tr_b16 v[126:127], v20 offset:37632
    v_mfma_f32_4x4x4_16b_bf16 v[88:91], v[36:37], v[136:137], v[88:91]
    v_mfma_f32_32x32x16_bf16 v[56:71], v[140:143], v[156:159], v[56:71]
    ds_read_b64_tr_b16 v[128:129], v20 offset:36928
    ds_read_b64_tr_b16 v[130:131], v20 offset:37696
    v_mfma_f32_4x4x4_16b_bf16 v[92:95], v[36:37], v[140:141], v[92:95]
    v_mfma_f32_32x32x16_bf16 v[72:87], v[144:147], v[156:159], v[72:87]
    ds_read_b64_tr_b16 v[132:133], v20 offset:36992
    ds_read_b64_tr_b16 v[134:135], v20 offset:37760
    v_mfma_f32_4x4x4_16b_bf16 v[96:99], v[36:37], v[144:145], v[96:99]
    s_waitcnt lgkmcnt(7)
    v_mfma_f32_32x32x16_bf16 v[40:55], v[112:115], v[160:163], v[40:55]
    ds_read_b64_tr_b16 v[136:137], v21 offset:36864
    ds_read_b64_tr_b16 v[138:139], v21 offset:37632
    v_mfma_f32_4x4x4_16b_bf16 v[88:91], v[36:37], v[114:115], v[88:91]
    v_mfma_f32_32x32x16_bf16 v[56:71], v[116:119], v[160:163], v[56:71]
    ds_read_b64_tr_b16 v[140:141], v21 offset:36928
    ds_read_b64_tr_b16 v[142:143], v21 offset:37696
    v_mfma_f32_4x4x4_16b_bf16 v[92:95], v[36:37], v[118:119], v[92:95]
    v_mfma_f32_32x32x16_bf16 v[72:87], v[120:123], v[160:163], v[72:87]
    ds_read_b64_tr_b16 v[144:145], v21 offset:36992
    ds_read_b64_tr_b16 v[146:147], v21 offset:37760
    v_mfma_f32_4x4x4_16b_bf16 v[96:99], v[36:37], v[122:123], v[96:99]
    s_waitcnt lgkmcnt(6)
    v_mfma_f32_32x32x16_bf16 v[40:55], v[124:127], v[164:167], v[40:55]
    ds_read_b64_tr_b16 v[112:113], v22 offset:36864
    ds_read_b64_tr_b16 v[114:115], v22 offset:37632
    v_mfma_f32_32x32x16_bf16 v[56:71], v[128:131], v[164:167], v[56:71]
    ds_read_b64_tr_b16 v[116:117], v22 offset:36928
    ds_read_b64_tr_b16 v[118:119], v22 offset:37696
    s_waitcnt vmcnt(5)
    ds_read_b128 v[148:151], v16 offset:32768
    v_mfma_f32_32x32x16_bf16 v[72:87], v[132:135], v[164:167], v[72:87]
    ds_read_b64_tr_b16 v[120:121], v22 offset:36992
    ds_read_b64_tr_b16 v[122:123], v22 offset:37760
    ds_read_b128 v[152:155], v17 offset:32768
    s_waitcnt lgkmcnt(8)
    v_mfma_f32_32x32x16_bf16 v[40:55], v[136:139], v[168:171], v[40:55]
    ds_read_b64_tr_b16 v[124:125], v23 offset:36864
    ds_read_b64_tr_b16 v[126:127], v23 offset:37632
    ds_read_b32 v31, v14
    ds_read_b128 v[156:159], v18 offset:32768
    v_mfma_f32_32x32x16_bf16 v[56:71], v[140:143], v[168:171], v[56:71]
    ds_read_b64_tr_b16 v[128:129], v23 offset:36928
    ds_read_b64_tr_b16 v[130:131], v23 offset:37696
    ds_read_b128 v[160:163], v19 offset:32768
    v_mov_b32 v13, 17
    ds_write_b32 v12, v13
    v_mfma_f32_32x32x16_bf16 v[72:87], v[144:147], v[168:171], v[72:87]
    ds_read_b64_tr_b16 v[132:133], v23 offset:36992
    ds_read_b64_tr_b16 v[134:135], v23 offset:37760
    v_mov_b32 v13, 18
    ds_write_b32 v12, v13
    s_waitcnt lgkmcnt(8)
    v_readfirstlane_b32 s48, v31
    s_cmp_ge_u32 s48, 10
    s_cbranch_scc0 L_rspin_71
L_rok_70:
    v_mfma_f32_32x32x16_bf16 v[40:55], v[112:115], v[172:175], v[40:55]
    ds_read_b64_tr_b16 v[136:137], v20 offset:0
    ds_read_b64_tr_b16 v[138:139], v20 offset:768
    v_mfma_f32_4x4x4_16b_bf16 v[88:91], v[36:37], v[112:113], v[88:91]
    v_mfma_f32_32x32x16_bf16 v[56:71], v[116:119], v[172:175], v[56:71]
    ds_read_b64_tr_b16 v[140:141], v20 offset:64
    ds_read_b64_tr_b16 v[142:143], v20 offset:832
    v_mfma_f32_4x4x4_16b_bf16 v[92:95], v[36:37], v[116:117], v[92:95]
    v_mfma_f32_32x32x16_bf16 v[72:87], v[120:123], v[172:175], v[72:87]
    ds_read_b64_tr_b16 v[144:145], v20 offset:128
    ds_read_b64_tr_b16 v[146:147], v20 offset:896
    v_mfma_f32_4x4x4_16b_bf16 v[96:99], v[36:37], v[120:121], v[96:99]
    buffer_load_dwordx4 v[8:11], v25, s[68:71], 0 offen sc1
    s_waitcnt lgkmcnt(7)
    v_mfma_f32_32x32x16_bf16 v[40:55], v[124:127], v[176:179], v[40:55]
    ds_read_b64_tr_b16 v[112:113], v21 offset:0
    ds_read_b64_tr_b16 v[114:115], v21 offset:768
    v_mfma_f32_4x4x4_16b_bf16 v[88:91], v[36:37], v[126:127], v[88:91]
    v_mfma_f32_32x32x16_bf16 v[56:71], v[128:131], v[176:179], v[56:71]
    ds_read_b64_tr_b16 v[116:117], v21 offset:64
    ds_read_b64_tr_b16 v[118:119], v21 offset:832
    v_mfma_f32_4x4x4_16b_bf16 v[92:95], v[36:37], v[130:131], v[92:95]
    v_mfma_f32_32x32x16_bf16 v[72:87], v[132:135], v[176:179], v[72:87]
    ds_read_b64_tr_b16 v[120:121], v21 offset:128
    ds_read_b64_tr_b16 v[122:123], v21 offset:896
    v_mfma_f32_4x4x4_16b_bf16 v[96:99], v[36:37], v[134:135], v[96:99]
    s_waitcnt lgkmcnt(6)
    v_mfma_f32_32x32x16_bf16 v[40:55], v[136:139], v[148:151], v[40:55]
    ds_read_b64_tr_b16 v[124:125], v22 offset:0
    ds_read_b64_tr_b16 v[126:127], v22 offset:768
    v_mfma_f32_32x32x16_bf16 v[56:71], v[140:143], v[148:151], v[56:71]
    ds_read_b64_tr_b16 v[128:129], v22 offset:64
    ds_read_b64_tr_b16 v[130:131], v22 offset:832
    s_waitcnt vmcnt(1)
    ds_read_b128 v[164:167], v16 offset:0
    v_mfma_f32_32x32x16_bf16 v[72:87], v[144:147], v[148:151], v[72:87]
    ds_read_b64_tr_b16 v[132:133], v22 offset:128
    ds_read_b64_tr_b16 v[134:135], v22 offset:896
    ds_read_b128 v[168:171], v17 offset:0
    s_waitcnt lgkmcnt(8)
    v_mfma_f32_32x32x16_bf16 v[40:55], v[112:115], v[152:155], v[40:55]
    ds_read_b64_tr_b16 v[136:137], v23 offset:0
    ds_read_b64_tr_b16 v[138:139], v23 offset:768
    ds_read_b32 v31, v14
    ds_read_b128 v[172:175], v18 offset:0
    v_mfma_f32_32x32x16_bf16 v[56:71], v[116:119], v[152:155], v[56:71]
    ds_read_b64_tr_b16 v[140:141], v23 offset:64
    ds_read_b64_tr_b16 v[142:143], v23 offset:832
    ds_read_b128 v[176:179], v19 offset:0
    v_mov_b32 v13, 19
    ds_write_b32 v12, v13
    v_mfma_f32_32x32x16_bf16 v[72:87], v[120:123], v[152:155], v[72:87]
    ds_read_b64_tr_b16 v[144:145], v23 offset:128
    ds_read_b64_tr_b16 v[146:147], v23 offset:896
    v_mov_b32 v13, 20
    ds_write_b32 v12, v13
    s_waitcnt lgkmcnt(8)
    v_readfirstlane_b32 s48, v31
    s_cmp_ge_u32 s48, 11
    s_cbranch_scc0 L_rspin_73
L_rok_72:
    v_mfma_f32_32x32x16_bf16 v[40:55], v[124:127], v[156:159], v[40:55]
    ds_read_b64_tr_b16 v[112:113], v20 offset:12288
    ds_read_b64_tr_b16 v[114:115], v20 offset:13056
    v_mfma_f32_4x4x4_16b_bf16 v[88:91], v[36:37], v[124:125], v[88:91]
    v_mfma_f32_32x32x16_bf16 v[56:71], v[128:131], v[156:159], v[56:71]
    ds_read_b64_tr_b16 v[116:117], v20 offset:12352
    ds_read_b64_tr_b16 v[118:119], v20 offset:13120
    v_mfma_f32_4x4x4_16b_bf16 v[92:95], v[36:37], v[128:129], v[92:95]
    v_mfma_f32_32x32x16_bf16 v[72:87], v[132:135], v[156:159], v[72:87]
    ds_read_b64_tr_b16 v[120:121], v20 offset:12416
    ds_read_b64_tr_b16 v[122:123], v20 offset:13184
    v_mfma_f32_4x4x4_16b_bf16 v[96:99], v[36:37], v[132:133], v[96:99]
    s_waitcnt lgkmcnt(7)
    v_mfma_f32_32x32x16_bf16 v[40:55], v[136:139], v[160:163], v[40:55]
    ds_read_b64_tr_b16 v[124:125], v21 offset:12288
    ds_read_b64_tr_b16 v[126:127], v21 offset:13056
    v_mfma_f32_4x4x4_16b_bf16 v[88:91], v[36:37], v[138:139], v[88:91]
    v_mfma_f32_32x32x16_bf16 v[56:71], v[140:143], v[160:163], v[56:71]
    ds_read_b64_tr_b16 v[128:129], v21 offset:12352
    ds_read_b64_tr_b16 v[130:131], v21 offset:13120
    v_mfma_f32_4x4x4_16b_bf16 v[92:95], v[36:37], v[142:143], v[92:95]
    v_mfma_f32_32x32x16_bf16 v[72:87], v[144:147], v[160:163], v[72:87]
    ds_read_b64_tr_b16 v[132:133], v21 offset:12416
    ds_read_b64_tr_b16 v[134:135], v21 offset:13184
    v_mfma_f32_4x4x4_16b_bf16 v[96:99], v[36:37], v[146:147], v[96:99]
    s_waitcnt lgkmcnt(6)
    v_mfma_f32_32x32x16_bf16 v[40:55], v[112:115], v[164:167], v[40:55]
    ds_read_b64_tr_b16 v[136:137], v22 offset:12288
    ds_read_b64_tr_b16 v[138:139], v22 offset:13056
    v_mfma_f32_4x4x4_16b_bf16 v[88:91], v[36:37], v[112:113], v[88:91]
    v_mfma_f32_32x32x16_bf16 v[56:71], v[116:119], v[164:167], v[56:71]
    ds_read_b64_tr_b16 v[140:141], v22 offset:12352
    ds_read_b64_tr_b16 v[142:143], v22 offset:13120
    v_mfma_f32_4x4x4_16b_bf16 v[92:95], v[36:37], v[116:117], v[92:95]
    s_waitcnt vmcnt(0)
    s_mov_b32 s54, 0
    s_branch L_gchk_76
L_gspin_75:
    s_sleep 1
    buffer_load_dwordx4 v[8:11], v25, s[68:71], 0 offen sc1
    s_add_u32 s54, s54, 1
    s_cmp_gt_u32 s54, 0x10000
    s_waitcnt vmcnt(0)
    s_cbranch_scc1 L_gok_74
L_gchk_76:
    v_cmp_ne_u64 vcc, v[10:11], v[4:5]
    s_cbranch_vccnz L_gspin_75
L_gok_74:
    v_mov_b32 v204, v8
    v_mov_b32 v205, v9
    v_mfma_f32_32x32x16_bf16 v[72:87], v[120:123], v[164:167], v[72:87]
    ds_read_b64_tr_b16 v[144:145], v22 offset:12416
    ds_read_b64_tr_b16 v[146:147], v22 offset:13184
    v_mfma_f32_4x4x4_16b_bf16 v[96:99], v[36:37], v[120:121], v[96:99]
    s_waitcnt lgkmcnt(6)
    v_mfma_f32_32x32x16_bf16 v[40:55], v[124:127], v[168:171], v[40:55]
    ds_read_b64_tr_b16 v[112:113], v23 offset:12288
    ds_read_b64_tr_b16 v[114:115], v23 offset:13056
    v_mfma_f32_4x4x4_16b_bf16 v[88:91], v[36:37], v[126:127], v[88:91]
    v_mfma_f32_32x32x16_bf16 v[56:71], v[128:131], v[168:171], v[56:71]
    ds_read_b64_tr_b16 v[116:117], v23 offset:12352
    ds_read_b64_tr_b16 v[118:119], v23 offset:13120
    v_mfma_f32_4x4x4_16b_bf16 v[92:95], v[36:37], v[130:131], v[92:95]
    v_mfma_f32_32x32x16_bf16 v[72:87], v[132:135], v[168:171], v[72:87]
    ds_read_b64_tr_b16 v[120:121], v23 offset:12416
    ds_read_b64_tr_b16 v[122:123], v23 offset:13184
    v_mfma_f32_4x4x4_16b_bf16 v[96:99], v[36:37], v[134:135], v[96:99]
    v_mov_b32 v13, 21
    ds_write_b32 v12, v13
    s_waitcnt lgkmcnt(7)
    v_mfma_f32_32x32x16_bf16 v[40:55], v[136:139], v[172:175], v[40:55]
    s_nop 1
    v_and_b32 v36, 0xffff0000, v205
    v_rcp_f32 v36, v36
    v_mfma_f32_32x32x16_bf16 v[56:71], v[140:143], v[172:175], v[56:71]
    v_permlane32_swap_b32 v88, v89
    v_permlane32_swap_b32 v92, v93
    v_permlane32_swap_b32 v96, v97
    v_add_f32 v88, v88, v89
    v_add_f32 v92, v92, v93
    v_add_f32 v96, v96, v97
    ds_write_b32 v26, v88 offset:0
    ds_write_b32 v26, v92 offset:128
    ds_write_b32 v26, v96 offset:256
    v_mov_b32 v13, 3
    ds_write_b32 v12, v13 offset:16
    v_mfma_f32_32x32x16_bf16 v[72:87], v[144:147], v[172:175], v[72:87]
    s_waitcnt lgkmcnt(5)
    v_mfma_f32_32x32x16_bf16 v[40:55], v[112:115], v[176:179], v[40:55]
    s_mov_b32 s54, 0
L_bspin_77:
    ds_read_b128 v[8:11], v14 offset:32
    s_add_u32 s54, s54, 1
    s_cmp_gt_u32 s54, 0x100000
    s_waitcnt lgkmcnt(0)
    v_min3_u32 v8, v8, v9, v10
    v_min_u32 v8, v8, v11
    s_cbranch_scc1 L_bok_78
    v_cmp_gt_u32 vcc, 3, v8
    s_cbranch_vccnz L_bspin_77
L_bok_78:
    ds_read_b32 v180, v27 offset:0
    ds_read_b32 v181, v27 offset:128
    ds_read_b32 v182, v27 offset:256
    ds_read_b32 v183, v27 offset:384
    ds_read_b32 v184, v27 offset:512
    ds_read_b32 v185, v27 offset:640
    ds_read_b32 v186, v27 offset:768
    ds_read_b32 v187, v27 offset:896
    ds_read_b32 v188, v27 offset:1024
    ds_read_b32 v189, v27 offset:1152
    ds_read_b32 v190, v27 offset:1280
    ds_read_b32 v191, v27 offset:1408
    v_mfma_f32_32x32x16_bf16 v[56:71], v[116:119], v[176:179], v[56:71]
    v_mfma_f32_32x32x16_bf16 v[72:87], v[120:123], v[176:179], v[72:87]
    v_mul_f32 v32, 0x3fb8aa3b, v36
    v_mul_f32 v34, -2.0, v36
    s_mov_b32 exec_hi, 0
    v_mov_b32 v193, v28
    v_mov_b32 v197, v29
    v_mov_b32 v201, v30
    s_waitcnt lgkmcnt(0)
    v_add_f32 v180, v180, v183
    v_add_f32 v186, v186, v189
    v_add_f32 v181, v181, v184
    v_add_f32 v187, v187, v190
    v_add_f32 v182, v182, v185
    v_add_f32 v188, v188, v191
    v_add_f32 v180, v180, v186
    v_add_f32 v181, v181, v187
    v_add_f32 v182, v182, v188
    v_cvt_pk_bf16_f32 v183, v180, v180
    v_cvt_pk_bf16_f32 v184, v181, v181
    v_cvt_pk_bf16_f32 v185, v182, v182
    v_and_b32 v183, 0xffff0000, v183
    v_and_b32 v184, 0xffff0000, v184
    v_and_b32 v185, 0xffff0000, v185
    v_sub_f32 v183, v180, v183
    v_sub_f32 v184, v181, v184
    v_sub_f32 v185, v182, v185
    v_cvt_pk_bf16_f32 v192, v180, v183
    v_cvt_pk_bf16_f32 v196, v181, v184
    v_cvt_pk_bf16_f32 v200, v182, v185
    s_mov_b32 exec_hi, -1
    s_nop 0
    v_mfma_f32_32x32x16_bf16 v[40:55], v[192:195], v[204:207], v[40:55]
    v_mfma_f32_32x32x16_bf16 v[56:71], v[196:199], v[204:207], v[56:71]
    v_mfma_f32_32x32x16_bf16 v[72:87], v[200:203], v[204:207], v[72:87]
    v_and_b32 v1, 15, v0
    v_lshrrev_b32 v2, 4, v0
    s_lshl2_add_u32 s44, s42, s3
    s_mul_i32 s45, s44, 20480
    s_mul_i32 s46, s43, 160
    s_add_u32 s50, s45, s46
    v_lshrrev_b32 v23, 2, v0
    v_lshlrev_b32 v23, 7, v23
    v_and_b32 v22, 3, v0
    v_lshl_add_u32 v23, v22, 3, v23
    s_lshl_b32 s46, s3, 5
    s_add_u32 s46, s46, 81920
    v_add_u32 v23, s46, v23
    s_lshl_b32 s44, s3, 10
    v_add_u32 v15, s44, v7
    v_add_u32 v27, 65536, v15
    v_pk_mul_f32 v[112:113], v[40:41], v[32:33] op_sel_hi:[1,0]
    v_pk_mul_f32 v[114:115], v[42:43], v[32:33] op_sel_hi:[1,0]
    v_pk_mul_f32 v[116:117], v[44:45], v[32:33] op_sel_hi:[1,0]
    v_pk_mul_f32 v[118:119], v[46:47], v[32:33] op_sel_hi:[1,0]
    v_exp_f32 v112, v112
    v_exp_f32 v113, v113
    v_exp_f32 v114, v114
    v_exp_f32 v115, v115
    v_exp_f32 v116, v116
    v_exp_f32 v117, v117
    v_exp_f32 v118, v118
    v_exp_f32 v119, v119
    v_pk_add_f32 v[120:121], v[112:113], s[58:59]
    v_pk_add_f32 v[122:123], v[114:115], s[58:59]
    v_pk_add_f32 v[124:125], v[116:117], s[58:59]
    v_pk_add_f32 v[126:127], v[118:119], s[58:59]
    v_pk_fma_f32 v[112:113], v[112:113], v[120:121], s[58:59]
    v_pk_fma_f32 v[114:115], v[114:115], v[122:123], s[58:59]
    v_pk_fma_f32 v[116:117], v[116:117], v[124:125], s[58:59]
    v_pk_fma_f32 v[118:119], v[118:119], v[126:127], s[58:59]
    v_rcp_f32 v112, v112
    v_rcp_f32 v113, v113
    v_rcp_f32 v114, v114
    v_rcp_f32 v115, v115
    v_rcp_f32 v116, v116
    v_rcp_f32 v117, v117
    v_rcp_f32 v118, v118
    v_rcp_f32 v119, v119
    v_pk_fma_f32 v[112:113], v[112:113], v[34:35], v[36:37] op_sel_hi:[1,0,0]
    v_pk_fma_f32 v[114:115], v[114:115], v[34:35], v[36:37] op_sel_hi:[1,0,0]
    v_pk_fma_f32 v[116:117], v[116:117], v[34:35], v[36:37] op_sel_hi:[1,0,0]
    v_pk_fma_f32 v[118:119], v[118:119], v[34:35], v[36:37] op_sel_hi:[1,0,0]
    v_pk_mul_f32 v[112:113], v[112:113], v[40:41]
    v_pk_mul_f32 v[114:115], v[114:115], v[42:43]
    v_pk_mul_f32 v[116:117], v[116:117], v[44:45]
    v_pk_mul_f32 v[118:119], v[118:119], v[46:47]
    v_cvt_pk_bf16_f32 v144, v112, v113
    v_cvt_pk_bf16_f32 v145, v114, v115
    v_cvt_pk_bf16_f32 v146, v116, v117
    v_cvt_pk_bf16_f32 v147, v118, v119
    buffer_store_dwordx4 v[144:147], v24, s[60:63], s47 offen offset:0 sc1
    v_pk_mul_f32 v[128:129], v[48:49], v[32:33] op_sel_hi:[1,0]
    v_pk_mul_f32 v[130:131], v[50:51], v[32:33] op_sel_hi:[1,0]
    v_pk_mul_f32 v[132:133], v[52:53], v[32:33] op_sel_hi:[1,0]
    v_pk_mul_f32 v[134:135], v[54:55], v[32:33] op_sel_hi:[1,0]
    v_exp_f32 v128, v128
    v_exp_f32 v129, v129
    v_exp_f32 v130, v130
    v_exp_f32 v131, v131
    v_exp_f32 v132, v132
    v_exp_f32 v133, v133
    v_exp_f32 v134, v134
    v_exp_f32 v135, v135
    v_pk_add_f32 v[136:137], v[128:129], s[58:59]
    v_pk_add_f32 v[138:139], v[130:131], s[58:59]
    v_pk_add_f32 v[140:141], v[132:133], s[58:59]
    v_pk_add_f32 v[142:143], v[134:135], s[58:59]
    v_pk_fma_f32 v[128:129], v[128:129], v[136:137], s[58:59]
    v_pk_fma_f32 v[130:131], v[130:131], v[138:139], s[58:59]
    v_pk_fma_f32 v[132:133], v[132:133], v[140:141], s[58:59]
    v_pk_fma_f32 v[134:135], v[134:135], v[142:143], s[58:59]
    v_rcp_f32 v128, v128
    v_rcp_f32 v129, v129
    v_rcp_f32 v130, v130
    v_rcp_f32 v131, v131
    v_rcp_f32 v132, v132
    v_rcp_f32 v133, v133
    v_rcp_f32 v134, v134
    v_rcp_f32 v135, v135
    v_pk_fma_f32 v[128:129], v[128:129], v[34:35], v[36:37] op_sel_hi:[1,0,0]
    v_pk_fma_f32 v[130:131], v[130:131], v[34:35], v[36:37] op_sel_hi:[1,0,0]
    v_pk_fma_f32 v[132:133], v[132:133], v[34:35], v[36:37] op_sel_hi:[1,0,0]
    v_pk_fma_f32 v[134:135], v[134:135], v[34:35], v[36:37] op_sel_hi:[1,0,0]
    v_pk_mul_f32 v[128:129], v[128:129], v[48:49]
    v_pk_mul_f32 v[130:131], v[130:131], v[50:51]
    v_pk_mul_f32 v[132:133], v[132:133], v[52:53]
    v_pk_mul_f32 v[134:135], v[134:135], v[54:55]
    v_cvt_pk_bf16_f32 v148, v128, v129
    v_cvt_pk_bf16_f32 v149, v130, v131
    v_cvt_pk_bf16_f32 v150, v132, v133
    v_cvt_pk_bf16_f32 v151, v134, v135
    buffer_store_dwordx4 v[148:151], v24, s[60:63], s47 offen offset:512 sc1
    v_pk_mul_f32 v[112:113], v[56:57], v[32:33] op_sel_hi:[1,0]
    v_pk_mul_f32 v[114:115], v[58:59], v[32:33] op_sel_hi:[1,0]
    v_pk_mul_f32 v[116:117], v[60:61], v[32:33] op_sel_hi:[1,0]
    v_pk_mul_f32 v[118:119], v[62:63], v[32:33] op_sel_hi:[1,0]
    v_exp_f32 v112, v112
    v_exp_f32 v113, v113
    v_exp_f32 v114, v114
    v_exp_f32 v115, v115
    v_exp_f32 v116, v116
    v_exp_f32 v117, v117
    v_exp_f32 v118, v118
    v_exp_f32 v119, v119
    v_pk_add_f32 v[120:121], v[112:113], s[58:59]
    v_pk_add_f32 v[122:123], v[114:115], s[58:59]
    v_pk_add_f32 v[124:125], v[116:117], s[58:59]
    v_pk_add_f32 v[126:127], v[118:119], s[58:59]
    v_pk_fma_f32 v[112:113], v[112:113], v[120:121], s[58:59]
    v_pk_fma_f32 v[114:115], v[114:115], v[122:123], s[58:59]
    v_pk_fma_f32 v[116:117], v[116:117], v[124:125], s[58:59]
    v_pk_fma_f32 v[118:119], v[118:119], v[126:127], s[58:59]
    v_rcp_f32 v112, v112
    v_rcp_f32 v113, v113
    v_rcp_f32 v114, v114
    v_rcp_f32 v115, v115
    v_rcp_f32 v116, v116
    v_rcp_f32 v117, v117
    v_rcp_f32 v118, v118
    v_rcp_f32 v119, v119
    v_pk_fma_f32 v[112:113], v[112:113], v[34:35], v[36:37] op_sel_hi:[1,0,0]
    v_pk_fma_f32 v[114:115], v[114:115], v[34:35], v[36:37] op_sel_hi:[1,0,0]
    v_pk_fma_f32 v[116:117], v[116:117], v[34:35], v[36:37] op_sel_hi:[1,0,0]
    v_pk_fma_f32 v[118:119], v[118:119], v[34:35], v[36:37] op_sel_hi:[1,0,0]
    v_pk_mul_f32 v[112:113], v[112:113], v[56:57]
    v_pk_mul_f32 v[114:115], v[114:115], v[58:59]
    v_pk_mul_f32 v[116:117], v[116:117], v[60:61]
    v_pk_mul_f32 v[118:119], v[118:119], v[62:63]
    v_cvt_pk_bf16_f32 v152, v112, v113
    v_cvt_pk_bf16_f32 v153, v114, v115
    v_cvt_pk_bf16_f32 v154, v116, v117
    v_cvt_pk_bf16_f32 v155, v118, v119
    buffer_store_dwordx4 v[152:155], v24, s[60:63], s47 offen offset:1024 sc1
    v_pk_mul_f32 v[128:129], v[64:65], v[32:33] op_sel_hi:[1,0]
    v_pk_mul_f32 v[130:131], v[66:67], v[32:33] op_sel_hi:[1,0]
    v_pk_mul_f32 v[132:133], v[68:69], v[32:33] op_sel_hi:[1,0]
    v_pk_mul_f32 v[134:135], v[70:71], v[32:33] op_sel_hi:[1,0]
    v_exp_f32 v128, v128
    v_exp_f32 v129, v129
    v_exp_f32 v130, v130
    v_exp_f32 v131, v131
    v_exp_f32 v132, v132
    v_exp_f32 v133, v133
    v_exp_f32 v134, v134
    v_exp_f32 v135, v135
    v_pk_add_f32 v[136:137], v[128:129], s[58:59]
    v_pk_add_f32 v[138:139], v[130:131], s[58:59]
    v_pk_add_f32 v[140:141], v[132:133], s[58:59]
    v_pk_add_f32 v[142:143], v[134:135], s[58:59]
    v_pk_fma_f32 v[128:129], v[128:129], v[136:137], s[58:59]
    v_pk_fma_f32 v[130:131], v[130:131], v[138:139], s[58:59]
    v_pk_fma_f32 v[132:133], v[132:133], v[140:141], s[58:59]
    v_pk_fma_f32 v[134:135], v[134:135], v[142:143], s[58:59]
    v_rcp_f32 v128, v128
    v_rcp_f32 v129, v129
    v_rcp_f32 v130, v130
    v_rcp_f32 v131, v131
    v_rcp_f32 v132, v132
    v_rcp_f32 v133, v133
    v_rcp_f32 v134, v134
    v_rcp_f32 v135, v135
    v_pk_fma_f32 v[128:129], v[128:129], v[34:35], v[36:37] op_sel_hi:[1,0,0]
    v_pk_fma_f32 v[130:131], v[130:131], v[34:35], v[36:37] op_sel_hi:[1,0,0]
    v_pk_fma_f32 v[132:133], v[132:133], v[34:35], v[36:37] op_sel_hi:[1,0,0]
    v_pk_fma_f32 v[134:135], v[134:135], v[34:35], v[36:37] op_sel_hi:[1,0,0]
    v_pk_mul_f32 v[128:129], v[128:129], v[64:65]
    v_pk_mul_f32 v[130:131], v[130:131], v[66:67]
    v_pk_mul_f32 v[132:133], v[132:133], v[68:69]
    v_pk_mul_f32 v[134:135], v[134:135], v[70:71]
    v_cvt_pk_bf16_f32 v156, v128, v129
    v_cvt_pk_bf16_f32 v157, v130, v131
    v_cvt_pk_bf16_f32 v158, v132, v133
    v_cvt_pk_bf16_f32 v159, v134, v135
    buffer_store_dwordx4 v[156:159], v24, s[60:63], s47 offen offset:1536 sc1
    v_pk_mul_f32 v[112:113], v[72:73], v[32:33] op_sel_hi:[1,0]
    v_pk_mul_f32 v[114:115], v[74:75], v[32:33] op_sel_hi:[1,0]
    v_pk_mul_f32 v[116:117], v[76:77], v[32:33] op_sel_hi:[1,0]
    v_pk_mul_f32 v[118:119], v[78:79], v[32:33] op_sel_hi:[1,0]
    v_exp_f32 v112, v112
    v_exp_f32 v113, v113
    v_exp_f32 v114, v114
    v_exp_f32 v115, v115
    v_exp_f32 v116, v116
    v_exp_f32 v117, v117
    v_exp_f32 v118, v118
    v_exp_f32 v119, v119
    v_pk_add_f32 v[120:121], v[112:113], s[58:59]
    v_pk_add_f32 v[122:123], v[114:115], s[58:59]
    v_pk_add_f32 v[124:125], v[116:117], s[58:59]
    v_pk_add_f32 v[126:127], v[118:119], s[58:59]
    v_pk_fma_f32 v[112:113], v[112:113], v[120:121], s[58:59]
    v_pk_fma_f32 v[114:115], v[114:115], v[122:123], s[58:59]
    v_pk_fma_f32 v[116:117], v[116:117], v[124:125], s[58:59]
    v_pk_fma_f32 v[118:119], v[118:119], v[126:127], s[58:59]
    v_rcp_f32 v112, v112
    v_rcp_f32 v113, v113
    v_rcp_f32 v114, v114
    v_rcp_f32 v115, v115
    v_rcp_f32 v116, v116
    v_rcp_f32 v117, v117
    v_rcp_f32 v118, v118
    v_rcp_f32 v119, v119
    v_pk_fma_f32 v[112:113], v[112:113], v[34:35], v[36:37] op_sel_hi:[1,0,0]
    v_pk_fma_f32 v[114:115], v[114:115], v[34:35], v[36:37] op_sel_hi:[1,0,0]
    v_pk_fma_f32 v[116:117], v[116:117], v[34:35], v[36:37] op_sel_hi:[1,0,0]
    v_pk_fma_f32 v[118:119], v[118:119], v[34:35], v[36:37] op_sel_hi:[1,0,0]
    v_pk_mul_f32 v[112:113], v[112:113], v[72:73]
    v_pk_mul_f32 v[114:115], v[114:115], v[74:75]
    v_pk_mul_f32 v[116:117], v[116:117], v[76:77]
    v_pk_mul_f32 v[118:119], v[118:119], v[78:79]
    v_cvt_pk_bf16_f32 v160, v112, v113
    v_cvt_pk_bf16_f32 v161, v114, v115
    v_cvt_pk_bf16_f32 v162, v116, v117
    v_cvt_pk_bf16_f32 v163, v118, v119
    buffer_store_dwordx4 v[160:163], v24, s[60:63], s47 offen offset:2048 sc1
    v_pk_mul_f32 v[128:129], v[80:81], v[32:33] op_sel_hi:[1,0]
    v_pk_mul_f32 v[130:131], v[82:83], v[32:33] op_sel_hi:[1,0]
    v_pk_mul_f32 v[132:133], v[84:85], v[32:33] op_sel_hi:[1,0]
    v_pk_mul_f32 v[134:135], v[86:87], v[32:33] op_sel_hi:[1,0]
    v_exp_f32 v128, v128
    v_exp_f32 v129, v129
    v_exp_f32 v130, v130
    v_exp_f32 v131, v131
    v_exp_f32 v132, v132
    v_exp_f32 v133, v133
    v_exp_f32 v134, v134
    v_exp_f32 v135, v135
    v_pk_add_f32 v[136:137], v[128:129], s[58:59]
    v_pk_add_f32 v[138:139], v[130:131], s[58:59]
    v_pk_add_f32 v[140:141], v[132:133], s[58:59]
    v_pk_add_f32 v[142:143], v[134:135], s[58:59]
    v_pk_fma_f32 v[128:129], v[128:129], v[136:137], s[58:59]
    v_pk_fma_f32 v[130:131], v[130:131], v[138:139], s[58:59]
    v_pk_fma_f32 v[132:133], v[132:133], v[140:141], s[58:59]
    v_pk_fma_f32 v[134:135], v[134:135], v[142:143], s[58:59]
    v_rcp_f32 v128, v128
    v_rcp_f32 v129, v129
    v_rcp_f32 v130, v130
    v_rcp_f32 v131, v131
    v_rcp_f32 v132, v132
    v_rcp_f32 v133, v133
    v_rcp_f32 v134, v134
    v_rcp_f32 v135, v135
    v_pk_fma_f32 v[128:129], v[128:129], v[34:35], v[36:37] op_sel_hi:[1,0,0]
    v_pk_fma_f32 v[130:131], v[130:131], v[34:35], v[36:37] op_sel_hi:[1,0,0]
    v_pk_fma_f32 v[132:133], v[132:133], v[34:35], v[36:37] op_sel_hi:[1,0,0]
    v_pk_fma_f32 v[134:135], v[134:135], v[34:35], v[36:37] op_sel_hi:[1,0,0]
    v_pk_mul_f32 v[128:129], v[128:129], v[80:81]
    v_pk_mul_f32 v[130:131], v[130:131], v[82:83]
    v_pk_mul_f32 v[132:133], v[132:133], v[84:85]
    v_pk_mul_f32 v[134:135], v[134:135], v[86:87]
    v_cvt_pk_bf16_f32 v164, v128, v129
    v_cvt_pk_bf16_f32 v165, v130, v131
    v_cvt_pk_bf16_f32 v166, v132, v133
    v_cvt_pk_bf16_f32 v167, v134, v135
    v_mov_b32 v13, 4
    ds_write_b32 v12, v13 offset:16
    buffer_store_dwordx4 v[164:167], v24, s[60:63], s47 offen offset:2560 sc1
    s_add_u32 s44, s3, 1
    s_and_b32 s44, s44, 3
    s_mul_i32 s44, s44, 15360
    s_add_u32 s44, s44, 0
    v_add_u32 v16, s44, v7
    s_add_u32 s44, s3, 2
    s_and_b32 s44, s44, 3
    s_mul_i32 s44, s44, 15360
    s_add_u32 s44, s44, 5120
    v_add_u32 v17, s44, v7
    s_add_u32 s44, s3, 3
    s_and_b32 s44, s44, 3
    s_mul_i32 s44, s44, 15360
    s_add_u32 s44, s44, 10240
    v_add_u32 v18, s44, v7
    s_mul_i32 s44, s3, 15360
    v_add_u32 v19, s44, v7
    s_mul_i32 s44, s3, 3072
    s_add_u32 s44, s44, 61440
    v_mul_u32_u24 v20, 176, v1
    v_lshl_add_u32 v20, v2, 3, v20
    v_add_u32 v20, s44, v20
    s_mov_b32 s51, s44
    v_mov_b32 v2, v27
    s_and_b32 s45, s43, 3
    s_mul_i32 s45, s45, 3
    s_and_b32 s25, s42, 7
    s_add_u32 s45, s45, s25
    s_lshr_b32 s25, s25, 1
    s_add_u32 s45, s45, s25
    s_sub_u32 s25, s45, 12
    s_cmp_ge_u32 s45, 12
    s_cselect_b32 s25, s25, s45
    s_lshl_b32 s25, s25, 10
    s_mul_i32 s45, s3, 12288
    s_add_u32 s44, s3, 0
    s_and_b32 s44, s44, 3
    s_lshl2_add_u32 s44, s42, s44
    s_mul_i32 s44, s44, 49152
    s_add_u32 s16, s44, s45
    s_add_u32 s44, s3, 1
    s_and_b32 s44, s44, 3
    s_lshl2_add_u32 s44, s42, s44
    s_mul_i32 s44, s44, 49152
    s_add_u32 s17, s44, s45
    s_add_u32 s44, s3, 2
    s_and_b32 s44, s44, 3
    s_lshl2_add_u32 s44, s42, s44
    s_mul_i32 s44, s44, 49152
    s_add_u32 s18, s44, s45
    s_add_u32 s44, s3, 3
    s_and_b32 s44, s44, 3
    s_lshl2_add_u32 s44, s42, s44
    s_mul_i32 s44, s44, 49152
    s_add_u32 s19, s44, s45
    s_mul_i32 s44, s43, 245760
    s_add_u32 s20, s44, s45
    s_add_u32 s21, s20, 49152
    s_add_u32 s22, s20, 98304
    s_add_u32 s23, s20, 147456
    s_add_u32 s24, s20, 196608
    s_waitcnt vmcnt(0)
    s_mov_b64 exec, 1
    buffer_store_dwordx2 v[4:5], v6, s[64:67], s49 offen offset:0 sc1
    s_mov_b64 exec, -1
    s_cmp_ge_u32 s48, 12
    s_cbranch_scc0 L_rspin_80
L_rok_79:
    ds_read_b128 v[208:211], v2 offset:0
    ds_read_b128 v[212:215], v2 offset:4096
    ds_read_b128 v[216:219], v2 offset:8192
    ds_read_b128 v[220:223], v2 offset:12288
    ds_read_b128 v[224:227], v15 offset:24576
    v_mov_b32 v13, 22
    ds_write_b32 v12, v13
    s_add_u32 s10, s25, 4096
    s_sub_u32 s11, s10, 12288
    s_cmp_ge_u32 s10, 12288
    s_cselect_b32 s10, s11, s10
    v_add_u32 v1, s10, v7
    buffer_load_dwordx4 v[228:231], v1, s[72:75], s20 offen sc1
    buffer_load_dwordx4 v[232:235], v1, s[72:75], s21 offen sc1
    buffer_load_dwordx4 v[236:239], v1, s[72:75], s22 offen sc1
    buffer_load_dwordx4 v[240:243], v1, s[72:75], s23 offen sc1
    buffer_load_dwordx4 v[244:247], v1, s[72:75], s24 offen sc1
    s_add_u32 s10, s25, 5120
    s_sub_u32 s11, s10, 12288
    s_cmp_ge_u32 s10, 12288
    s_cselect_b32 s10, s11, s10
    v_add_u32 v1, s10, v7
    buffer_load_dwordx4 v[248:251], v1, s[72:75], s20 offen sc1
    buffer_load_dwordx4 v[252:255], v1, s[72:75], s21 offen sc1
    buffer_load_dwordx4 v[168:171], v1, s[72:75], s22 offen sc1
    buffer_load_dwordx4 v[172:175], v1, s[72:75], s23 offen sc1
    buffer_load_dwordx4 v[176:179], v1, s[72:75], s24 offen sc1
    s_add_u32 s10, s25, 6144
    s_sub_u32 s11, s10, 12288
    s_cmp_ge_u32 s10, 12288
    s_cselect_b32 s10, s11, s10
    v_add_u32 v1, s10, v7
    buffer_load_dwordx4 v[180:183], v1, s[72:75], s20 offen sc1
    buffer_load_dwordx4 v[184:187], v1, s[72:75], s21 offen sc1
    buffer_load_dwordx4 v[188:191], v1, s[72:75], s22 offen sc1
    buffer_load_dwordx4 v[192:195], v1, s[72:75], s23 offen sc1
    buffer_load_dwordx4 v[196:199], v1, s[72:75], s24 offen sc1
    s_cmp_ge_u32 s48, 16
    s_cbranch_scc0 L_rspin_82
L_rok_81:
    s_add_u32 s10, s25, 0
    s_sub_u32 s11, s10, 12288
    s_cmp_ge_u32 s10, 12288
    s_cselect_b32 s10, s11, s10
    v_add_u32 v1, s10, v7
    buffer_load_dwordx4 v[200:203], v1, s[60:63], s16 offen sc1
    buffer_load_dwordx4 v[204:207], v1, s[60:63], s17 offen sc1
    buffer_load_dwordx4 v[104:107], v1, s[60:63], s18 offen sc1
    buffer_load_dwordx4 v[108:111], v1, s[60:63], s19 offen sc1
    s_add_u32 s10, s25, 1024
    s_sub_u32 s11, s10, 12288
    s_cmp_ge_u32 s10, 12288
    s_cselect_b32 s10, s11, s10
    v_add_u32 v1, s10, v7
    buffer_load_dwordx4 v[112:115], v1, s[60:63], s16 offen sc1
    buffer_load_dwordx4 v[116:119], v1, s[60:63], s17 offen sc1
    buffer_load_dwordx4 v[120:123], v1, s[60:63], s18 offen sc1
    buffer_load_dwordx4 v[124:127], v1, s[60:63], s19 offen sc1
    s_add_u32 s10, s25, 2048
    s_sub_u32 s11, s10, 12288
    s_cmp_ge_u32 s10, 12288
    s_cselect_b32 s10, s11, s10
    v_add_u32 v1, s10, v7
    buffer_load_dwordx4 v[128:131], v1, s[60:63], s16 offen sc1
    buffer_load_dwordx4 v[132:135], v1, s[60:63], s17 offen sc1
    buffer_load_dwordx4 v[136:139], v1, s[60:63], s18 offen sc1
    buffer_load_dwordx4 v[140:143], v1, s[60:63], s19 offen sc1
    s_add_u32 s10, s25, 3072
    s_sub_u32 s11, s10, 12288
    s_cmp_ge_u32 s10, 12288
    s_cselect_b32 s10, s11, s10
    v_add_u32 v1, s10, v7
    buffer_load_dwordx4 v[144:147], v1, s[60:63], s16 offen sc1
    s_waitcnt vmcnt(9) lgkmcnt(1)
    v_mfma_f32_16x16x32_bf16 v[24:27], v[208:211], v[200:203], 0
    ds_read_b32 v11, v14
    v_mfma_f32_16x16x32_bf16 v[28:31], v[212:215], v[200:203], 0
    s_waitcnt lgkmcnt(0)
    v_readfirstlane_b32 s48, v11
    s_cmp_ge_u32 s48, 13
    s_cbranch_scc0 L_rspin_84
L_rok_83:
    v_mfma_f32_16x16x32_bf16 v[32:35], v[216:219], v[200:203], 0
    ds_read_b128 v[148:151], v15 offset:28672
    v_mfma_f32_16x16x32_bf16 v[36:39], v[220:223], v[200:203], 0
    ds_read_b128 v[152:155], v15 offset:32768
    v_mfma_f32_16x16x32_bf16 v[40:43], v[224:227], v[200:203], 0
    ds_read_b128 v[156:159], v2 offset:16384
    v_mfma_f32_16x16x32_bf16 v[44:47], v[208:211], v[204:207], 0
    ds_read_b128 v[160:163], v2 offset:20480
    v_mfma_f32_16x16x32_bf16 v[48:51], v[212:215], v[204:207], 0
    ds_read_b128 v[164:167], v2 offset:24576
    v_mfma_f32_16x16x32_bf16 v[52:55], v[216:219], v[204:207], 0
    v_mov_b32 v13, 23
    ds_write_b32 v12, v13
    v_mfma_f32_16x16x32_bf16 v[56:59], v[220:223], v[204:207], 0
    v_mfma_f32_16x16x32_bf16 v[60:63], v[224:227], v[204:207], 0
    v_mfma_f32_16x16x32_bf16 v[64:67], v[208:211], v[104:107], 0
    v_mfma_f32_16x16x32_bf16 v[68:71], v[212:215], v[104:107], 0
    v_mfma_f32_16x16x32_bf16 v[72:75], v[216:219], v[104:107], 0
    v_mfma_f32_16x16x32_bf16 v[76:79], v[220:223], v[104:107], 0
    v_mfma_f32_16x16x32_bf16 v[80:83], v[224:227], v[104:107], 0
    v_mfma_f32_16x16x32_bf16 v[84:87], v[208:211], v[108:111], 0
    v_mfma_f32_16x16x32_bf16 v[88:91], v[212:215], v[108:111], 0
    v_mfma_f32_16x16x32_bf16 v[92:95], v[216:219], v[108:111], 0
    v_mfma_f32_16x16x32_bf16 v[96:99], v[220:223], v[108:111], 0
    v_mfma_f32_16x16x32_bf16 v[100:103], v[224:227], v[108:111], 0
    s_waitcnt vmcnt(5) lgkmcnt(1)
    v_mfma_f32_16x16x32_bf16 v[24:27], v[148:151], v[112:115], v[24:27]
    ds_read_b32 v11, v14
    v_mfma_f32_16x16x32_bf16 v[28:31], v[152:155], v[112:115], v[28:31]
    buffer_load_dwordx4 v[212:215], v1, s[60:63], s17 offen sc1
    v_mfma_f32_16x16x32_bf16 v[32:35], v[156:159], v[112:115], v[32:35]
    buffer_load_dwordx4 v[216:219], v1, s[60:63], s18 offen sc1
    v_mfma_f32_16x16x32_bf16 v[36:39], v[160:163], v[112:115], v[36:39]
    buffer_load_dwordx4 v[220:223], v1, s[60:63], s19 offen sc1
    v_mfma_f32_16x16x32_bf16 v[40:43], v[164:167], v[112:115], v[40:43]
    s_waitcnt lgkmcnt(0)
    v_readfirstlane_b32 s48, v11
    s_cmp_ge_u32 s48, 14
    s_cbranch_scc0 L_rspin_86
L_rok_85:
    v_mfma_f32_16x16x32_bf16 v[44:47], v[148:151], v[116:119], v[44:47]
    ds_read_b128 v[200:203], v2 offset:28672
    v_mfma_f32_16x16x32_bf16 v[48:51], v[152:155], v[116:119], v[48:51]
    ds_read_b128 v[204:207], v15 offset:36864
    v_mfma_f32_16x16x32_bf16 v[52:55], v[156:159], v[116:119], v[52:55]
    ds_read_b128 v[104:107], v15 offset:40960
    v_mfma_f32_16x16x32_bf16 v[56:59], v[160:163], v[116:119], v[56:59]
    ds_read_b128 v[108:111], v15 offset:45056
    v_mfma_f32_16x16x32_bf16 v[60:63], v[164:167], v[116:119], v[60:63]
    ds_read_b128 v[208:211], v15 offset:49152
    v_mfma_f32_16x16x32_bf16 v[64:67], v[148:151], v[120:123], v[64:67]
    v_mov_b32 v13, 24
    ds_write_b32 v12, v13
    v_mfma_f32_16x16x32_bf16 v[68:71], v[152:155], v[120:123], v[68:71]
    s_add_u32 s10, s25, 4096
    s_sub_u32 s11, s10, 12288
    s_cmp_ge_u32 s10, 12288
    s_cselect_b32 s10, s11, s10
    v_add_u32 v1, s10, v7
    buffer_load_dwordx4 v[224:227], v1, s[60:63], s16 offen sc1
    v_mfma_f32_16x16x32_bf16 v[72:75], v[156:159], v[120:123], v[72:75]
    v_mfma_f32_16x16x32_bf16 v[76:79], v[160:163], v[120:123], v[76:79]
    v_mfma_f32_16x16x32_bf16 v[80:83], v[164:167], v[120:123], v[80:83]
    v_mfma_f32_16x16x32_bf16 v[84:87], v[148:151], v[124:127], v[84:87]
    v_mfma_f32_16x16x32_bf16 v[88:91], v[152:155], v[124:127], v[88:91]
    v_mfma_f32_16x16x32_bf16 v[92:95], v[156:159], v[124:127], v[92:95]
    v_mfma_f32_16x16x32_bf16 v[96:99], v[160:163], v[124:127], v[96:99]
    v_mfma_f32_16x16x32_bf16 v[100:103], v[164:167], v[124:127], v[100:103]
    s_waitcnt vmcnt(5) lgkmcnt(1)
    v_mfma_f32_16x16x32_bf16 v[24:27], v[200:203], v[128:131], v[24:27]
    ds_read_b32 v11, v14
    v_mfma_f32_16x16x32_bf16 v[28:31], v[204:207], v[128:131], v[28:31]
    buffer_load_dwordx4 v[152:155], v1, s[60:63], s17 offen sc1
    v_mfma_f32_16x16x32_bf16 v[32:35], v[104:107], v[128:131], v[32:35]
    buffer_load_dwordx4 v[156:159], v1, s[60:63], s18 offen sc1
    v_mfma_f32_16x16x32_bf16 v[36:39], v[108:111], v[128:131], v[36:39]
    buffer_load_dwordx4 v[160:163], v1, s[60:63], s19 offen sc1
    v_mfma_f32_16x16x32_bf16 v[40:43], v[208:211], v[128:131], v[40:43]
    s_waitcnt lgkmcnt(0)
    v_readfirstlane_b32 s48, v11
    s_cmp_ge_u32 s48, 15
    s_cbranch_scc0 L_rspin_88
L_rok_87:
    v_mfma_f32_16x16x32_bf16 v[44:47], v[200:203], v[132:135], v[44:47]
    ds_read_b128 v[112:115], v15 offset:53248
    v_mfma_f32_16x16x32_bf16 v[48:51], v[204:207], v[132:135], v[48:51]
    ds_read_b128 v[116:119], v15 offset:57344
    v_mfma_f32_16x16x32_bf16 v[52:55], v[104:107], v[132:135], v[52:55]
    ds_read_b128 v[120:123], v15 offset:61440
    v_mfma_f32_16x16x32_bf16 v[56:59], v[108:111], v[132:135], v[56:59]
    ds_read_b128 v[124:127], v15 offset:0
    v_mfma_f32_16x16x32_bf16 v[60:63], v[208:211], v[132:135], v[60:63]
    ds_read_b128 v[148:151], v15 offset:4096
    v_mfma_f32_16x16x32_bf16 v[64:67], v[200:203], v[136:139], v[64:67]
    v_mov_b32 v13, 25
    ds_write_b32 v12, v13
    v_mfma_f32_16x16x32_bf16 v[68:71], v[204:207], v[136:139], v[68:71]
    s_add_u32 s10, s25, 5120
    s_sub_u32 s11, s10, 12288
    s_cmp_ge_u32 s10, 12288
    s_cselect_b32 s10, s11, s10
    v_add_u32 v1, s10, v7
    buffer_load_dwordx4 v[164:167], v1, s[60:63], s16 offen sc1
    v_mfma_f32_16x16x32_bf16 v[72:75], v[104:107], v[136:139], v[72:75]
    v_mfma_f32_16x16x32_bf16 v[76:79], v[108:111], v[136:139], v[76:79]
    v_mfma_f32_16x16x32_bf16 v[80:83], v[208:211], v[136:139], v[80:83]
    v_mfma_f32_16x16x32_bf16 v[84:87], v[200:203], v[140:143], v[84:87]
    v_mfma_f32_16x16x32_bf16 v[88:91], v[204:207], v[140:143], v[88:91]
    v_mfma_f32_16x16x32_bf16 v[92:95], v[104:107], v[140:143], v[92:95]
    v_mfma_f32_16x16x32_bf16 v[96:99], v[108:111], v[140:143], v[96:99]
    v_mfma_f32_16x16x32_bf16 v[100:103], v[208:211], v[140:143], v[100:103]
    s_waitcnt vmcnt(5) lgkmcnt(1)
    v_mfma_f32_16x16x32_bf16 v[24:27], v[112:115], v[144:147], v[24:27]
    buffer_load_dwordx4 v[128:131], v1, s[60:63], s17 offen sc1
    v_mfma_f32_16x16x32_bf16 v[28:31], v[116:119], v[144:147], v[28:31]
    buffer_load_dwordx4 v[132:135], v1, s[60:63], s18 offen sc1
    v_mfma_f32_16x16x32_bf16 v[32:35], v[120:123], v[144:147], v[32:35]
    buffer_load_dwordx4 v[136:139], v1, s[60:63], s19 offen sc1
    v_mfma_f32_16x16x32_bf16 v[36:39], v[124:127], v[144:147], v[36:39]
    s_add_u32 s10, s25, 6144
    s_sub_u32 s11, s10, 12288
    s_cmp_ge_u32 s10, 12288
    s_cselect_b32 s10, s11, s10
    v_add_u32 v1, s10, v7
    buffer_load_dwordx4 v[140:143], v1, s[60:63], s16 offen sc1
    v_mfma_f32_16x16x32_bf16 v[40:43], v[148:151], v[144:147], v[40:43]
    buffer_load_dwordx4 v[200:203], v1, s[60:63], s17 offen sc1
    v_mfma_f32_16x16x32_bf16 v[44:47], v[112:115], v[212:215], v[44:47]
    buffer_load_dwordx4 v[204:207], v1, s[60:63], s18 offen sc1
    v_mfma_f32_16x16x32_bf16 v[48:51], v[116:119], v[212:215], v[48:51]
    buffer_load_dwordx4 v[104:107], v1, s[60:63], s19 offen sc1
    v_mfma_f32_16x16x32_bf16 v[52:55], v[120:123], v[212:215], v[52:55]
    s_add_u32 s10, s25, 7168
    s_sub_u32 s11, s10, 12288
    s_cmp_ge_u32 s10, 12288
    s_cselect_b32 s10, s11, s10
    v_add_u32 v1, s10, v7
    buffer_load_dwordx4 v[108:111], v1, s[60:63], s16 offen sc1
    v_mfma_f32_16x16x32_bf16 v[56:59], v[124:127], v[212:215], v[56:59]
    buffer_load_dwordx4 v[208:211], v1, s[60:63], s17 offen sc1
    v_mfma_f32_16x16x32_bf16 v[60:63], v[148:151], v[212:215], v[60:63]
    v_mfma_f32_16x16x32_bf16 v[64:67], v[112:115], v[216:219], v[64:67]
    v_mfma_f32_16x16x32_bf16 v[68:71], v[116:119], v[216:219], v[68:71]
    v_mfma_f32_16x16x32_bf16 v[72:75], v[120:123], v[216:219], v[72:75]
    v_mfma_f32_16x16x32_bf16 v[76:79], v[124:127], v[216:219], v[76:79]
    v_mfma_f32_16x16x32_bf16 v[80:83], v[148:151], v[216:219], v[80:83]
    v_mfma_f32_16x16x32_bf16 v[84:87], v[112:115], v[220:223], v[84:87]
    v_mfma_f32_16x16x32_bf16 v[88:91], v[116:119], v[220:223], v[88:91]
    v_mfma_f32_16x16x32_bf16 v[92:95], v[120:123], v[220:223], v[92:95]
    v_mfma_f32_16x16x32_bf16 v[96:99], v[124:127], v[220:223], v[96:99]
    v_mfma_f32_16x16x32_bf16 v[100:103], v[148:151], v[220:223], v[100:103]
    s_waitcnt vmcnt(10)
    v_mfma_f32_16x16x32_bf16 v[24:27], v[228:231], v[224:227], v[24:27]
    buffer_load_dwordx4 v[144:147], v1, s[60:63], s18 offen sc1
    v_mfma_f32_16x16x32_bf16 v[28:31], v[232:235], v[224:227], v[28:31]
    buffer_load_dwordx4 v[212:215], v1, s[60:63], s19 offen sc1
    v_mfma_f32_16x16x32_bf16 v[32:35], v[236:239], v[224:227], v[32:35]
    s_add_u32 s10, s25, 8192
    s_sub_u32 s11, s10, 12288
    s_cmp_ge_u32 s10, 12288
    s_cselect_b32 s10, s11, s10
    v_add_u32 v1, s10, v7
    buffer_load_dwordx4 v[216:219], v1, s[60:63], s16 offen sc1
    v_mfma_f32_16x16x32_bf16 v[36:39], v[240:243], v[224:227], v[36:39]
    buffer_load_dwordx4 v[220:223], v1, s[60:63], s17 offen sc1
    v_mfma_f32_16x16x32_bf16 v[40:43], v[244:247], v[224:227], v[40:43]
    buffer_load_dwordx4 v[112:115], v1, s[60:63], s18 offen sc1
    v_mfma_f32_16x16x32_bf16 v[44:47], v[228:231], v[152:155], v[44:47]
    buffer_load_dwordx4 v[116:119], v1, s[60:63], s19 offen sc1
    v_mfma_f32_16x16x32_bf16 v[48:51], v[232:235], v[152:155], v[48:51]
    s_add_u32 s10, s25, 9216
    s_sub_u32 s11, s10, 12288
    s_cmp_ge_u32 s10, 12288
    s_cselect_b32 s10, s11, s10
    v_add_u32 v1, s10, v7
    buffer_load_dwordx4 v[120:123], v1, s[60:63], s16 offen sc1
    v_mfma_f32_16x16x32_bf16 v[52:55], v[236:239], v[152:155], v[52:55]
    buffer_load_dwordx4 v[124:127], v1, s[60:63], s17 offen sc1
    v_mfma_f32_16x16x32_bf16 v[56:59], v[240:243], v[152:155], v[56:59]
    buffer_load_dwordx4 v[148:151], v1, s[60:63], s18 offen sc1
    v_mfma_f32_16x16x32_bf16 v[60:63], v[244:247], v[152:155], v[60:63]
    v_mfma_f32_16x16x32_bf16 v[64:67], v[228:231], v[156:159], v[64:67]
    v_mfma_f32_16x16x32_bf16 v[68:71], v[232:235], v[156:159], v[68:71]
    v_mfma_f32_16x16x32_bf16 v[72:75], v[236:239], v[156:159], v[72:75]
    v_mfma_f32_16x16x32_bf16 v[76:79], v[240:243], v[156:159], v[76:79]
    v_mfma_f32_16x16x32_bf16 v[80:83], v[244:247], v[156:159], v[80:83]
    v_mfma_f32_16x16x32_bf16 v[84:87], v[228:231], v[160:163], v[84:87]
    v_mfma_f32_16x16x32_bf16 v[88:91], v[232:235], v[160:163], v[88:91]
    v_mfma_f32_16x16x32_bf16 v[92:95], v[236:239], v[160:163], v[92:95]
    v_mfma_f32_16x16x32_bf16 v[96:99], v[240:243], v[160:163], v[96:99]
    v_mfma_f32_16x16x32_bf16 v[100:103], v[244:247], v[160:163], v[100:103]
    s_waitcnt vmcnt(15)
    v_mfma_f32_16x16x32_bf16 v[24:27], v[248:251], v[164:167], v[24:27]
    buffer_load_dwordx4 v[224:227], v1, s[60:63], s19 offen sc1
    v_mfma_f32_16x16x32_bf16 v[28:31], v[252:255], v[164:167], v[28:31]
    s_add_u32 s10, s25, 10240
    s_sub_u32 s11, s10, 12288
    s_cmp_ge_u32 s10, 12288
    s_cselect_b32 s10, s11, s10
    v_add_u32 v1, s10, v7
    buffer_load_dwordx4 v[152:155], v1, s[60:63], s16 offen sc1
    v_mfma_f32_16x16x32_bf16 v[32:35], v[168:171], v[164:167], v[32:35]
    buffer_load_dwordx4 v[156:159], v1, s[60:63], s17 offen sc1
    v_mfma_f32_16x16x32_bf16 v[36:39], v[172:175], v[164:167], v[36:39]
    buffer_load_dwordx4 v[160:163], v1, s[60:63], s18 offen sc1
    v_mfma_f32_16x16x32_bf16 v[40:43], v[176:179], v[164:167], v[40:43]
    buffer_load_dwordx4 v[228:231], v1, s[60:63], s19 offen sc1
    v_mfma_f32_16x16x32_bf16 v[44:47], v[248:251], v[128:131], v[44:47]
    s_add_u32 s10, s25, 11264
    s_sub_u32 s11, s10, 12288
    s_cmp_ge_u32 s10, 12288
    s_cselect_b32 s10, s11, s10
    v_add_u32 v1, s10, v7
    buffer_load_dwordx4 v[232:235], v1, s[60:63], s16 offen sc1
    v_mfma_f32_16x16x32_bf16 v[48:51], v[252:255], v[128:131], v[48:51]
    buffer_load_dwordx4 v[236:239], v1, s[60:63], s17 offen sc1
    v_mfma_f32_16x16x32_bf16 v[52:55], v[168:171], v[128:131], v[52:55]
    buffer_load_dwordx4 v[240:243], v1, s[60:63], s18 offen sc1
    v_mfma_f32_16x16x32_bf16 v[56:59], v[172:175], v[128:131], v[56:59]
    buffer_load_dwordx4 v[244:247], v1, s[60:63], s19 offen sc1
    v_mfma_f32_16x16x32_bf16 v[60:63], v[176:179], v[128:131], v[60:63]
    v_mfma_f32_16x16x32_bf16 v[64:67], v[248:251], v[132:135], v[64:67]
    v_mfma_f32_16x16x32_bf16 v[68:71], v[252:255], v[132:135], v[68:71]
    v_mfma_f32_16x16x32_bf16 v[72:75], v[168:171], v[132:135], v[72:75]
    v_mfma_f32_16x16x32_bf16 v[76:79], v[172:175], v[132:135], v[76:79]
    v_mfma_f32_16x16x32_bf16 v[80:83], v[176:179], v[132:135], v[80:83]
    v_mfma_f32_16x16x32_bf16 v[84:87], v[248:251], v[136:139], v[84:87]
    v_mfma_f32_16x16x32_bf16 v[88:91], v[252:255], v[136:139], v[88:91]
    v_mfma_f32_16x16x32_bf16 v[92:95], v[168:171], v[136:139], v[92:95]
    v_mfma_f32_16x16x32_bf16 v[96:99], v[172:175], v[136:139], v[96:99]
    v_mfma_f32_16x16x32_bf16 v[100:103], v[176:179], v[136:139], v[100:103]
    s_waitcnt vmcnt(20)
    v_mfma_f32_16x16x32_bf16 v[24:27], v[180:183], v[140:143], v[24:27]
    ds_read_b32 v11, v14
    v_mfma_f32_16x16x32_bf16 v[28:31], v[184:187], v[140:143], v[28:31]
    buffer_load_dwordx4 v[252:255], v1, s[72:75], s20 offen sc1
    v_mfma_f32_16x16x32_bf16 v[32:35], v[188:191], v[140:143], v[32:35]
    buffer_load_dwordx4 v[168:171], v1, s[72:75], s21 offen sc1
    v_mfma_f32_16x16x32_bf16 v[36:39], v[192:195], v[140:143], v[36:39]
    buffer_load_dwordx4 v[172:175], v1, s[72:75], s22 offen sc1
    v_mfma_f32_16x16x32_bf16 v[40:43], v[196:199], v[140:143], v[40:43]
    s_waitcnt lgkmcnt(0)
    v_readfirstlane_b32 s48, v11
    s_cmp_ge_u32 s48, 17
    s_cbranch_scc0 L_rspin_90
L_rok_89:
    v_mfma_f32_16x16x32_bf16 v[44:47], v[180:183], v[200:203], v[44:47]
    ds_read_b128 v[164:167], v15 offset:8192
    v_mfma_f32_16x16x32_bf16 v[48:51], v[184:187], v[200:203], v[48:51]
    ds_read_b128 v[128:131], v15 offset:12288
    v_mfma_f32_16x16x32_bf16 v[52:55], v[188:191], v[200:203], v[52:55]
    ds_read_b128 v[132:135], v15 offset:16384
    v_mfma_f32_16x16x32_bf16 v[56:59], v[192:195], v[200:203], v[56:59]
    ds_read_b128 v[136:139], v15 offset:20480
    v_mfma_f32_16x16x32_bf16 v[60:63], v[196:199], v[200:203], v[60:63]
    ds_read_b128 v[248:251], v2 offset:0
    v_mfma_f32_16x16x32_bf16 v[64:67], v[180:183], v[204:207], v[64:67]
    v_mov_b32 v13, 26
    ds_write_b32 v12, v13
    v_mfma_f32_16x16x32_bf16 v[68:71], v[184:187], v[204:207], v[68:71]
    buffer_load_dwordx4 v[176:179], v1, s[72:75], s23 offen sc1
    v_mfma_f32_16x16x32_bf16 v[72:75], v[188:191], v[204:207], v[72:75]
    v_mfma_f32_16x16x32_bf16 v[76:79], v[192:195], v[204:207], v[76:79]
    v_mfma_f32_16x16x32_bf16 v[80:83], v[196:199], v[204:207], v[80:83]
    v_mfma_f32_16x16x32_bf16 v[84:87], v[180:183], v[104:107], v[84:87]
    v_mfma_f32_16x16x32_bf16 v[88:91], v[184:187], v[104:107], v[88:91]
    v_mfma_f32_16x16x32_bf16 v[92:95], v[188:191], v[104:107], v[92:95]
    v_mfma_f32_16x16x32_bf16 v[96:99], v[192:195], v[104:107], v[96:99]
    v_mfma_f32_16x16x32_bf16 v[100:103], v[196:199], v[104:107], v[100:103]
    s_waitcnt vmcnt(20) lgkmcnt(1)
    v_mfma_f32_16x16x32_bf16 v[24:27], v[164:167], v[108:111], v[24:27]
    ds_read_b32 v11, v14
    v_mfma_f32_16x16x32_bf16 v[28:31], v[128:131], v[108:111], v[28:31]
    buffer_load_dwordx4 v[184:187], v1, s[72:75], s24 offen sc1
    v_mfma_f32_16x16x32_bf16 v[32:35], v[132:135], v[108:111], v[32:35]
    s_waitcnt lgkmcnt(0)
    v_readfirstlane_b32 s48, v11
    s_cmp_ge_u32 s48, 18
    s_cbranch_scc0 L_rspin_92
L_rok_91:
    v_mfma_f32_16x16x32_bf16 v[36:39], v[136:139], v[108:111], v[36:39]
    ds_read_b128 v[140:143], v2 offset:4096
    v_mfma_f32_16x16x32_bf16 v[40:43], v[248:251], v[108:111], v[40:43]
    ds_read_b128 v[200:203], v2 offset:8192
    v_mfma_f32_16x16x32_bf16 v[44:47], v[164:167], v[208:211], v[44:47]
    ds_read_b128 v[204:207], v2 offset:12288
    v_mfma_f32_16x16x32_bf16 v[48:51], v[128:131], v[208:211], v[48:51]
    ds_read_b128 v[104:107], v15 offset:24576
    v_mfma_f32_16x16x32_bf16 v[52:55], v[132:135], v[208:211], v[52:55]
    ds_read_b128 v[180:183], v15 offset:28672
    v_mfma_f32_16x16x32_bf16 v[56:59], v[136:139], v[208:211], v[56:59]
    v_mov_b32 v13, 27
    ds_write_b32 v12, v13
    v_mfma_f32_16x16x32_bf16 v[60:63], v[248:251], v[208:211], v[60:63]
    v_mfma_f32_16x16x32_bf16 v[64:67], v[164:167], v[144:147], v[64:67]
    v_mfma_f32_16x16x32_bf16 v[68:71], v[128:131], v[144:147], v[68:71]
    v_mfma_f32_16x16x32_bf16 v[72:75], v[132:135], v[144:147], v[72:75]
    v_mfma_f32_16x16x32_bf16 v[76:79], v[136:139], v[144:147], v[76:79]
    v_mfma_f32_16x16x32_bf16 v[80:83], v[248:251], v[144:147], v[80:83]
    v_mfma_f32_16x16x32_bf16 v[84:87], v[164:167], v[212:215], v[84:87]
    v_mfma_f32_16x16x32_bf16 v[88:91], v[128:131], v[212:215], v[88:91]
    v_mfma_f32_16x16x32_bf16 v[92:95], v[132:135], v[212:215], v[92:95]
    v_mfma_f32_16x16x32_bf16 v[96:99], v[136:139], v[212:215], v[96:99]
    v_mfma_f32_16x16x32_bf16 v[100:103], v[248:251], v[212:215], v[100:103]
    s_waitcnt vmcnt(17) lgkmcnt(1)
    v_mfma_f32_16x16x32_bf16 v[24:27], v[140:143], v[216:219], v[24:27]
    ds_read_b32 v11, v14
    v_mfma_f32_16x16x32_bf16 v[28:31], v[200:203], v[216:219], v[28:31]
    s_waitcnt lgkmcnt(0)
    v_readfirstlane_b32 s48, v11
    s_cmp_ge_u32 s48, 19
    s_cbranch_scc0 L_rspin_94
L_rok_93:
    v_mfma_f32_16x16x32_bf16 v[32:35], v[204:207], v[216:219], v[32:35]
    ds_read_b128 v[188:191], v15 offset:32768
    v_mfma_f32_16x16x32_bf16 v[36:39], v[104:107], v[216:219], v[36:39]
    ds_read_b128 v[192:195], v2 offset:28672
    v_mfma_f32_16x16x32_bf16 v[40:43], v[180:183], v[216:219], v[40:43]
    ds_read_b128 v[196:199], v15 offset:36864
    v_mfma_f32_16x16x32_bf16 v[44:47], v[140:143], v[220:223], v[44:47]
    ds_read_b128 v[108:111], v15 offset:40960
    v_mfma_f32_16x16x32_bf16 v[48:51], v[200:203], v[220:223], v[48:51]
    ds_read_b128 v[208:211], v15 offset:45056
    v_mfma_f32_16x16x32_bf16 v[52:55], v[204:207], v[220:223], v[52:55]
    v_mov_b32 v13, 28
    ds_write_b32 v12, v13
    v_mfma_f32_16x16x32_bf16 v[56:59], v[104:107], v[220:223], v[56:59]
    v_mfma_f32_16x16x32_bf16 v[60:63], v[180:183], v[220:223], v[60:63]
    v_mfma_f32_16x16x32_bf16 v[64:67], v[140:143], v[112:115], v[64:67]
    v_mfma_f32_16x16x32_bf16 v[68:71], v[200:203], v[112:115], v[68:71]
    v_mfma_f32_16x16x32_bf16 v[72:75], v[204:207], v[112:115], v[72:75]
    v_mfma_f32_16x16x32_bf16 v[76:79], v[104:107], v[112:115], v[76:79]
    v_mfma_f32_16x16x32_bf16 v[80:83], v[180:183], v[112:115], v[80:83]
    v_mfma_f32_16x16x32_bf16 v[84:87], v[140:143], v[116:119], v[84:87]
    v_mfma_f32_16x16x32_bf16 v[88:91], v[200:203], v[116:119], v[88:91]
    v_mfma_f32_16x16x32_bf16 v[92:95], v[204:207], v[116:119], v[92:95]
    v_mfma_f32_16x16x32_bf16 v[96:99], v[104:107], v[116:119], v[96:99]
    v_mfma_f32_16x16x32_bf16 v[100:103], v[180:183], v[116:119], v[100:103]
    s_waitcnt vmcnt(13) lgkmcnt(1)
    v_mfma_f32_16x16x32_bf16 v[24:27], v[188:191], v[120:123], v[24:27]
    ds_read_b32 v11, v14
    v_mfma_f32_16x16x32_bf16 v[28:31], v[192:195], v[120:123], v[28:31]
    s_waitcnt lgkmcnt(0)
    v_readfirstlane_b32 s48, v11
    s_cmp_ge_u32 s48, 20
    s_cbranch_scc0 L_rspin_96
L_rok_95:
    v_mfma_f32_16x16x32_bf16 v[32:35], v[196:199], v[120:123], v[32:35]
    ds_read_b128 v[144:147], v15 offset:49152
    v_mfma_f32_16x16x32_bf16 v[36:39], v[108:111], v[120:123], v[36:39]
    ds_read_b128 v[212:215], v15 offset:53248
    v_mfma_f32_16x16x32_bf16 v[40:43], v[208:211], v[120:123], v[40:43]
    ds_read_b128 v[164:167], v15 offset:57344
    v_mfma_f32_16x16x32_bf16 v[44:47], v[188:191], v[124:127], v[44:47]
    ds_read_b128 v[128:131], v15 offset:61440
    v_mfma_f32_16x16x32_bf16 v[48:51], v[192:195], v[124:127], v[48:51]
    ds_read_b128 v[132:135], v15 offset:0
    v_mfma_f32_16x16x32_bf16 v[52:55], v[196:199], v[124:127], v[52:55]
    v_mov_b32 v13, 29
    ds_write_b32 v12, v13
    v_mfma_f32_16x16x32_bf16 v[56:59], v[108:111], v[124:127], v[56:59]
    v_add_u32 v3, 0, v0
    v_mul_u32_u24 v21, 6554, v3
    v_lshrrev_b32 v21, 16, v21
    v_lshlrev_b32 v3, 4, v3
    v_mad_u32_u24 v140, v21, 16, v3
    v_mul_u32_u24 v21, 1120, v21
    v_add_u32 v200, v21, v3
    v_add_u32 v140, s51, v140
    buffer_load_dwordx4 v[180:183], v200, s[12:15], s50 offen
    v_mfma_f32_16x16x32_bf16 v[60:63], v[208:211], v[124:127], v[60:63]
    v_add_u32 v3, 64, v0
    v_mul_u32_u24 v21, 6554, v3
    v_lshrrev_b32 v21, 16, v21
    v_lshlrev_b32 v3, 4, v3
    v_mad_u32_u24 v141, v21, 16, v3
    v_mul_u32_u24 v21, 1120, v21
    v_add_u32 v201, v21, v3
    v_add_u32 v141, s51, v141
    buffer_load_dwordx4 v[104:107], v201, s[12:15], s50 offen
    v_mfma_f32_16x16x32_bf16 v[64:67], v[188:191], v[148:151], v[64:67]
    v_add_u32 v3, 128, v0
    v_mul_u32_u24 v21, 6554, v3
    v_lshrrev_b32 v21, 16, v21
    v_lshlrev_b32 v3, 4, v3
    v_mad_u32_u24 v142, v21, 16, v3
    v_mul_u32_u24 v21, 1120, v21
    v_add_u32 v202, v21, v3
    v_add_u32 v142, s51, v142
    buffer_load_dwordx4 v[204:207], v202, s[12:15], s50 offen
    v_mfma_f32_16x16x32_bf16 v[68:71], v[192:195], v[148:151], v[68:71]
    v_mfma_f32_16x16x32_bf16 v[72:75], v[196:199], v[148:151], v[72:75]
    v_mfma_f32_16x16x32_bf16 v[76:79], v[108:111], v[148:151], v[76:79]
    v_mfma_f32_16x16x32_bf16 v[80:83], v[208:211], v[148:151], v[80:83]
    v_mfma_f32_16x16x32_bf16 v[84:87], v[188:191], v[224:227], v[84:87]
    v_mfma_f32_16x16x32_bf16 v[88:91], v[192:195], v[224:227], v[88:91]
    v_mfma_f32_16x16x32_bf16 v[92:95], v[196:199], v[224:227], v[92:95]
    v_mfma_f32_16x16x32_bf16 v[96:99], v[108:111], v[224:227], v[96:99]
    v_mfma_f32_16x16x32_bf16 v[100:103], v[208:211], v[224:227], v[100:103]
    s_waitcnt vmcnt(12) lgkmcnt(1)
    v_mfma_f32_16x16x32_bf16 v[24:27], v[144:147], v[152:155], v[24:27]
    v_mfma_f32_16x16x32_bf16 v[28:31], v[212:215], v[152:155], v[28:31]
    v_mfma_f32_16x16x32_bf16 v[32:35], v[164:167], v[152:155], v[32:35]
    v_mfma_f32_16x16x32_bf16 v[36:39], v[128:131], v[152:155], v[36:39]
    v_mfma_f32_16x16x32_bf16 v[40:43], v[132:135], v[152:155], v[40:43]
    v_mfma_f32_16x16x32_bf16 v[44:47], v[144:147], v[156:159], v[44:47]
    v_mfma_f32_16x16x32_bf16 v[48:51], v[212:215], v[156:159], v[48:51]
    v_mfma_f32_16x16x32_bf16 v[52:55], v[164:167], v[156:159], v[52:55]
    v_mfma_f32_16x16x32_bf16 v[56:59], v[128:131], v[156:159], v[56:59]
    v_mfma_f32_16x16x32_bf16 v[60:63], v[132:135], v[156:159], v[60:63]
    v_mfma_f32_16x16x32_bf16 v[64:67], v[144:147], v[160:163], v[64:67]
    v_mfma_f32_16x16x32_bf16 v[68:71], v[212:215], v[160:163], v[68:71]
    v_mfma_f32_16x16x32_bf16 v[72:75], v[164:167], v[160:163], v[72:75]
    v_mfma_f32_16x16x32_bf16 v[76:79], v[128:131], v[160:163], v[76:79]
    v_mfma_f32_16x16x32_bf16 v[80:83], v[132:135], v[160:163], v[80:83]
    v_mfma_f32_16x16x32_bf16 v[84:87], v[144:147], v[228:231], v[84:87]
    v_mfma_f32_16x16x32_bf16 v[88:91], v[212:215], v[228:231], v[88:91]
    v_mfma_f32_16x16x32_bf16 v[92:95], v[164:167], v[228:231], v[92:95]
    v_mfma_f32_16x16x32_bf16 v[96:99], v[128:131], v[228:231], v[96:99]
    v_mfma_f32_16x16x32_bf16 v[100:103], v[132:135], v[228:231], v[100:103]
    s_waitcnt vmcnt(3)
    v_mfma_f32_16x16x32_bf16 v[44:47], v[252:255], v[236:239], v[44:47]
    v_mov_b32 v13, 5
    ds_write_b32 v12, v13 offset:16
    v_mfma_f32_16x16x32_bf16 v[48:51], v[168:171], v[236:239], v[48:51]
    v_mfma_f32_16x16x32_bf16 v[52:55], v[172:175], v[236:239], v[52:55]
    v_mfma_f32_16x16x32_bf16 v[56:59], v[176:179], v[236:239], v[56:59]
    v_mfma_f32_16x16x32_bf16 v[60:63], v[184:187], v[236:239], v[60:63]
    v_mfma_f32_16x16x32_bf16 v[64:67], v[252:255], v[240:243], v[64:67]
    v_mfma_f32_16x16x32_bf16 v[68:71], v[168:171], v[240:243], v[68:71]
    v_mfma_f32_16x16x32_bf16 v[72:75], v[172:175], v[240:243], v[72:75]
    v_mfma_f32_16x16x32_bf16 v[76:79], v[176:179], v[240:243], v[76:79]
    v_mfma_f32_16x16x32_bf16 v[80:83], v[184:187], v[240:243], v[80:83]
    v_mfma_f32_16x16x32_bf16 v[84:87], v[252:255], v[244:247], v[84:87]
    v_mfma_f32_16x16x32_bf16 v[88:91], v[168:171], v[244:247], v[88:91]
    v_mfma_f32_16x16x32_bf16 v[92:95], v[172:175], v[244:247], v[92:95]
    v_mfma_f32_16x16x32_bf16 v[96:99], v[176:179], v[244:247], v[96:99]
    v_mfma_f32_16x16x32_bf16 v[100:103], v[184:187], v[244:247], v[100:103]
    v_mfma_f32_16x16x32_bf16 v[24:27], v[252:255], v[232:235], v[24:27]
    v_mfma_f32_16x16x32_bf16 v[28:31], v[168:171], v[232:235], v[28:31]
    v_mfma_f32_16x16x32_bf16 v[32:35], v[172:175], v[232:235], v[32:35]
    v_mfma_f32_16x16x32_bf16 v[36:39], v[176:179], v[232:235], v[36:39]
    v_mfma_f32_16x16x32_bf16 v[40:43], v[184:187], v[232:235], v[40:43]
    s_mov_b32 s54, 0
L_bspin_97:
    ds_read_b128 v[8:11], v14 offset:32
    s_add_u32 s54, s54, 1
    s_cmp_gt_u32 s54, 0x100000
    s_waitcnt lgkmcnt(0)
    v_min3_u32 v8, v8, v9, v10
    v_min_u32 v8, v8, v11
    s_cbranch_scc1 L_bok_98
    v_cmp_gt_u32 vcc, 5, v8
    s_cbranch_vccnz L_bspin_97
L_bok_98:
    ds_write_b128 v16, v[44:47] offset:0
    ds_write_b128 v16, v[48:51] offset:1024
    ds_write_b128 v16, v[52:55] offset:2048
    ds_write_b128 v16, v[56:59] offset:3072
    ds_write_b128 v16, v[60:63] offset:4096
    ds_write_b128 v17, v[64:67] offset:0
    ds_write_b128 v17, v[68:71] offset:1024
    ds_write_b128 v17, v[72:75] offset:2048
    ds_write_b128 v17, v[76:79] offset:3072
    ds_write_b128 v17, v[80:83] offset:4096
    ds_write_b128 v18, v[84:87] offset:0
    ds_write_b128 v18, v[88:91] offset:1024
    ds_write_b128 v18, v[92:95] offset:2048
    ds_write_b128 v18, v[96:99] offset:3072
    ds_write_b128 v18, v[100:103] offset:4096
    v_mov_b32 v13, 6
    ds_write_b32 v12, v13 offset:16
    s_waitcnt vmcnt(0)
    v_lshlrev_b32 v136, 16, v180
    v_and_b32 v137, 0xffff0000, v180
    v_lshlrev_b32 v138, 16, v181
    v_and_b32 v139, 0xffff0000, v181
    v_lshlrev_b32 v248, 16, v182
    v_and_b32 v249, 0xffff0000, v182
    v_lshlrev_b32 v250, 16, v183
    v_and_b32 v251, 0xffff0000, v183
    v_lshlrev_b32 v216, 16, v104
    v_and_b32 v217, 0xffff0000, v104
    v_lshlrev_b32 v218, 16, v105
    v_and_b32 v219, 0xffff0000, v105
    v_lshlrev_b32 v220, 16, v106
    v_and_b32 v221, 0xffff0000, v106
    v_lshlrev_b32 v222, 16, v107
    v_and_b32 v223, 0xffff0000, v107
    v_lshlrev_b32 v112, 16, v204
    v_and_b32 v113, 0xffff0000, v204
    v_lshlrev_b32 v114, 16, v205
    v_and_b32 v115, 0xffff0000, v205
    v_lshlrev_b32 v116, 16, v206
    v_and_b32 v117, 0xffff0000, v206
    v_lshlrev_b32 v118, 16, v207
    v_and_b32 v119, 0xffff0000, v207
    s_cmp_ge_u32 s48, 21
    s_cbranch_scc0 L_rspin_100
L_rok_99:
    ds_read_b64_tr_b16 v[120:121], v23 offset:0
    ds_read_b64_tr_b16 v[122:123], v23 offset:2048
    ds_read_b64_tr_b16 v[124:125], v23 offset:4096
    ds_read_b64_tr_b16 v[126:127], v23 offset:6144
    ds_read_b64_tr_b16 v[148:149], v23 offset:8192
    s_mov_b32 s54, 0
L_bspin_101:
    ds_read_b128 v[8:11], v14 offset:32
    s_add_u32 s54, s54, 1
    s_cmp_gt_u32 s54, 0x100000
    s_waitcnt lgkmcnt(0)
    v_min3_u32 v8, v8, v9, v10
    v_min_u32 v8, v8, v11
    s_cbranch_scc1 L_bok_102
    v_cmp_gt_u32 vcc, 6, v8
    s_cbranch_vccnz L_bspin_101
L_bok_102:
    ds_read_b128 v[224:227], v19 offset:0
    ds_read_b128 v[188:191], v19 offset:5120
    ds_read_b128 v[192:195], v19 offset:10240
    ds_read_b128 v[196:199], v19 offset:1024
    ds_read_b128 v[108:111], v19 offset:6144
    ds_read_b128 v[208:211], v19 offset:11264
    ds_read_b128 v[152:155], v19 offset:2048
    ds_read_b128 v[156:159], v19 offset:7168
    ds_read_b128 v[160:163], v19 offset:12288
    ds_read_b128 v[228:231], v19 offset:3072
    ds_read_b128 v[144:147], v19 offset:8192
    ds_read_b128 v[212:215], v19 offset:13312
    ds_read_b128 v[164:167], v19 offset:4096
    ds_read_b128 v[128:131], v19 offset:9216
    ds_read_b128 v[132:135], v19 offset:14336
    v_lshlrev_b32 v76, 16, v120
    v_and_b32 v77, 0xffff0000, v120
    v_lshlrev_b32 v78, 16, v121
    v_and_b32 v79, 0xffff0000, v121
    v_lshlrev_b32 v80, 16, v122
    v_and_b32 v81, 0xffff0000, v122
    v_lshlrev_b32 v82, 16, v123
    v_and_b32 v83, 0xffff0000, v123
    v_lshlrev_b32 v84, 16, v124
    v_and_b32 v85, 0xffff0000, v124
    v_lshlrev_b32 v86, 16, v125
    v_and_b32 v87, 0xffff0000, v125
    v_lshlrev_b32 v88, 16, v126
    v_and_b32 v89, 0xffff0000, v126
    v_lshlrev_b32 v90, 16, v127
    v_and_b32 v91, 0xffff0000, v127
    v_lshlrev_b32 v92, 16, v148
    v_and_b32 v93, 0xffff0000, v148
    v_lshlrev_b32 v94, 16, v149
    v_and_b32 v95, 0xffff0000, v149
    s_waitcnt lgkmcnt(12)
    v_pk_add_f32 v[224:225], v[224:225], v[188:189]
    v_pk_add_f32 v[24:25], v[24:25], v[192:193]
    v_pk_add_f32 v[226:227], v[226:227], v[190:191]
    v_pk_add_f32 v[26:27], v[26:27], v[194:195]
    v_pk_add_f32 v[24:25], v[24:25], v[224:225]
    v_pk_add_f32 v[26:27], v[26:27], v[226:227]
    v_pk_mul_f32 v[44:45], v[24:25], s[56:57] neg_lo:[0,1] neg_hi:[0,1]
    v_pk_mul_f32 v[46:47], v[26:27], s[56:57] neg_lo:[0,1] neg_hi:[0,1]
    v_exp_f32 v44, v44
    v_exp_f32 v45, v45
    v_exp_f32 v46, v46
    v_exp_f32 v47, v47
    v_pk_mul_f32 v[24:25], v[24:25], v[76:77]
    v_pk_mul_f32 v[26:27], v[26:27], v[78:79]
    v_add_f32 v44, 1.0, v44
    v_add_f32 v45, 1.0, v45
    v_add_f32 v46, 1.0, v46
    v_add_f32 v47, 1.0, v47
    v_rcp_f32 v44, v44
    v_rcp_f32 v45, v45
    v_rcp_f32 v46, v46
    v_rcp_f32 v47, v47
    s_nop 0
    v_pk_mul_f32 v[24:25], v[24:25], v[44:45]
    v_pk_mul_f32 v[26:27], v[26:27], v[46:47]
    v_cvt_pk_bf16_f32 v44, v24, v25
    v_cvt_pk_bf16_f32 v45, v26, v27
    ds_write_b64 v20, v[44:45] offset:0
    s_waitcnt lgkmcnt(10)
    v_pk_add_f32 v[196:197], v[196:197], v[108:109]
    v_pk_add_f32 v[28:29], v[28:29], v[208:209]
    v_pk_add_f32 v[198:199], v[198:199], v[110:111]
    v_pk_add_f32 v[30:31], v[30:31], v[210:211]
    v_pk_add_f32 v[28:29], v[28:29], v[196:197]
    v_pk_add_f32 v[30:31], v[30:31], v[198:199]
    v_pk_mul_f32 v[48:49], v[28:29], s[56:57] neg_lo:[0,1] neg_hi:[0,1]
    v_pk_mul_f32 v[50:51], v[30:31], s[56:57] neg_lo:[0,1] neg_hi:[0,1]
    v_exp_f32 v48, v48
    v_exp_f32 v49, v49
    v_exp_f32 v50, v50
    v_exp_f32 v51, v51
    v_pk_mul_f32 v[28:29], v[28:29], v[80:81]
    v_pk_mul_f32 v[30:31], v[30:31], v[82:83]
    v_add_f32 v48, 1.0, v48
    v_add_f32 v49, 1.0, v49
    v_add_f32 v50, 1.0, v50
    v_add_f32 v51, 1.0, v51
    v_rcp_f32 v48, v48
    v_rcp_f32 v49, v49
    v_rcp_f32 v50, v50
    v_rcp_f32 v51, v51
    s_nop 0
    v_pk_mul_f32 v[28:29], v[28:29], v[48:49]
    v_pk_mul_f32 v[30:31], v[30:31], v[50:51]
    v_cvt_pk_bf16_f32 v48, v28, v29
    v_cvt_pk_bf16_f32 v49, v30, v31
    ds_write_b64 v20, v[48:49] offset:32
    s_waitcnt lgkmcnt(8)
    v_pk_add_f32 v[152:153], v[152:153], v[156:157]
    v_pk_add_f32 v[32:33], v[32:33], v[160:161]
    v_pk_add_f32 v[154:155], v[154:155], v[158:159]
    v_pk_add_f32 v[34:35], v[34:35], v[162:163]
    v_pk_add_f32 v[32:33], v[32:33], v[152:153]
    v_pk_add_f32 v[34:35], v[34:35], v[154:155]
    v_pk_mul_f32 v[52:53], v[32:33], s[56:57] neg_lo:[0,1] neg_hi:[0,1]
    v_pk_mul_f32 v[54:55], v[34:35], s[56:57] neg_lo:[0,1] neg_hi:[0,1]
    v_exp_f32 v52, v52
    v_exp_f32 v53, v53
    v_exp_f32 v54, v54
    v_exp_f32 v55, v55
    v_pk_mul_f32 v[32:33], v[32:33], v[84:85]
    v_pk_mul_f32 v[34:35], v[34:35], v[86:87]
    v_add_f32 v52, 1.0, v52
    v_add_f32 v53, 1.0, v53
    v_add_f32 v54, 1.0, v54
    v_add_f32 v55, 1.0, v55
    v_rcp_f32 v52, v52
    v_rcp_f32 v53, v53
    v_rcp_f32 v54, v54
    v_rcp_f32 v55, v55
    s_nop 0
    v_pk_mul_f32 v[32:33], v[32:33], v[52:53]
    v_pk_mul_f32 v[34:35], v[34:35], v[54:55]
    v_cvt_pk_bf16_f32 v52, v32, v33
    v_cvt_pk_bf16_f32 v53, v34, v35
    ds_write_b64 v20, v[52:53] offset:64
    s_waitcnt lgkmcnt(6)
    v_pk_add_f32 v[228:229], v[228:229], v[144:145]
    v_pk_add_f32 v[36:37], v[36:37], v[212:213]
    v_pk_add_f32 v[230:231], v[230:231], v[146:147]
    v_pk_add_f32 v[38:39], v[38:39], v[214:215]
    v_pk_add_f32 v[36:37], v[36:37], v[228:229]
    v_pk_add_f32 v[38:39], v[38:39], v[230:231]
    v_pk_mul_f32 v[56:57], v[36:37], s[56:57] neg_lo:[0,1] neg_hi:[0,1]
    v_pk_mul_f32 v[58:59], v[38:39], s[56:57] neg_lo:[0,1] neg_hi:[0,1]
    v_exp_f32 v56, v56
    v_exp_f32 v57, v57
    v_exp_f32 v58, v58
    v_exp_f32 v59, v59
    v_pk_mul_f32 v[36:37], v[36:37], v[88:89]
    v_pk_mul_f32 v[38:39], v[38:39], v[90:91]
    v_add_f32 v56, 1.0, v56
    v_add_f32 v57, 1.0, v57
    v_add_f32 v58, 1.0, v58
    v_add_f32 v59, 1.0, v59
    v_rcp_f32 v56, v56
    v_rcp_f32 v57, v57
    v_rcp_f32 v58, v58
    v_rcp_f32 v59, v59
    s_nop 0
    v_pk_mul_f32 v[36:37], v[36:37], v[56:57]
    v_pk_mul_f32 v[38:39], v[38:39], v[58:59]
    v_cvt_pk_bf16_f32 v56, v36, v37
    v_cvt_pk_bf16_f32 v57, v38, v39
    ds_write_b64 v20, v[56:57] offset:96
    s_waitcnt lgkmcnt(4)
    v_pk_add_f32 v[164:165], v[164:165], v[128:129]
    v_pk_add_f32 v[40:41], v[40:41], v[132:133]
    v_pk_add_f32 v[166:167], v[166:167], v[130:131]
    v_pk_add_f32 v[42:43], v[42:43], v[134:135]
    v_pk_add_f32 v[40:41], v[40:41], v[164:165]
    v_pk_add_f32 v[42:43], v[42:43], v[166:167]
    v_pk_mul_f32 v[60:61], v[40:41], s[56:57] neg_lo:[0,1] neg_hi:[0,1]
    v_pk_mul_f32 v[62:63], v[42:43], s[56:57] neg_lo:[0,1] neg_hi:[0,1]
    v_exp_f32 v60, v60
    v_exp_f32 v61, v61
    v_exp_f32 v62, v62
    v_exp_f32 v63, v63
    v_pk_mul_f32 v[40:41], v[40:41], v[92:93]
    v_pk_mul_f32 v[42:43], v[42:43], v[94:95]
    v_add_f32 v60, 1.0, v60
    v_add_f32 v61, 1.0, v61
    v_add_f32 v62, 1.0, v62
    v_add_f32 v63, 1.0, v63
    v_rcp_f32 v60, v60
    v_rcp_f32 v61, v61
    v_rcp_f32 v62, v62
    v_rcp_f32 v63, v63
    s_nop 0
    v_pk_mul_f32 v[40:41], v[40:41], v[60:61]
    v_pk_mul_f32 v[42:43], v[42:43], v[62:63]
    v_cvt_pk_bf16_f32 v60, v40, v41
    v_cvt_pk_bf16_f32 v61, v42, v43
    ds_write_b64 v20, v[60:61] offset:128
    ds_read_b128 v[64:67], v140
    ds_read_b128 v[68:71], v141
    ds_read_b128 v[72:75], v142
    s_waitcnt lgkmcnt(2)
    v_lshlrev_b32 v224, 16, v64
    v_and_b32 v225, 0xffff0000, v64
    v_lshlrev_b32 v226, 16, v65
    v_and_b32 v227, 0xffff0000, v65
    v_lshlrev_b32 v188, 16, v66
    v_and_b32 v189, 0xffff0000, v66
    v_lshlrev_b32 v190, 16, v67
    v_and_b32 v191, 0xffff0000, v67
    v_pk_add_f32 v[136:137], v[136:137], v[224:225]
    v_pk_add_f32 v[138:139], v[138:139], v[226:227]
    v_pk_add_f32 v[248:249], v[248:249], v[188:189]
    v_pk_add_f32 v[250:251], v[250:251], v[190:191]
    v_cvt_pk_bf16_f32 v180, v136, v137
    v_cvt_pk_bf16_f32 v181, v138, v139
    v_cvt_pk_bf16_f32 v182, v248, v249
    v_cvt_pk_bf16_f32 v183, v250, v251
    buffer_store_dwordx4 v[180:183], v200, s[76:79], s50 offen
    s_waitcnt lgkmcnt(1)
    v_lshlrev_b32 v192, 16, v68
    v_and_b32 v193, 0xffff0000, v68
    v_lshlrev_b32 v194, 16, v69
    v_and_b32 v195, 0xffff0000, v69
    v_lshlrev_b32 v196, 16, v70
    v_and_b32 v197, 0xffff0000, v70
    v_lshlrev_b32 v198, 16, v71
    v_and_b32 v199, 0xffff0000, v71
    v_pk_add_f32 v[216:217], v[216:217], v[192:193]
    v_pk_add_f32 v[218:219], v[218:219], v[194:195]
    v_pk_add_f32 v[220:221], v[220:221], v[196:197]
    v_pk_add_f32 v[222:223], v[222:223], v[198:199]
    v_cvt_pk_bf16_f32 v104, v216, v217
    v_cvt_pk_bf16_f32 v105, v218, v219
    v_cvt_pk_bf16_f32 v106, v220, v221
    v_cvt_pk_bf16_f32 v107, v222, v223
    buffer_store_dwordx4 v[104:107], v201, s[76:79], s50 offen
    s_waitcnt lgkmcnt(0)
    v_lshlrev_b32 v108, 16, v72
    v_and_b32 v109, 0xffff0000, v72
    v_lshlrev_b32 v110, 16, v73
    v_and_b32 v111, 0xffff0000, v73
    v_lshlrev_b32 v208, 16, v74
    v_and_b32 v209, 0xffff0000, v74
    v_lshlrev_b32 v210, 16, v75
    v_and_b32 v211, 0xffff0000, v75
    v_pk_add_f32 v[112:113], v[112:113], v[108:109]
    v_pk_add_f32 v[114:115], v[114:115], v[110:111]
    v_pk_add_f32 v[116:117], v[116:117], v[208:209]
    v_pk_add_f32 v[118:119], v[118:119], v[210:211]
    v_cvt_pk_bf16_f32 v204, v112, v113
    v_cvt_pk_bf16_f32 v205, v114, v115
    v_cvt_pk_bf16_f32 v206, v116, v117
    v_cvt_pk_bf16_f32 v207, v118, v119
    s_mov_b32 exec_hi, 0
    buffer_store_dwordx4 v[204:207], v202, s[76:79], s50 offen
    s_endpgm
L_rspin_45:
    s_mov_b32 s52, 1
    s_call_b64 s[100:101], L_c_spin
    s_branch L_rok_44
L_rspin_47:
    s_mov_b32 s52, 2
    s_call_b64 s[100:101], L_c_spin
    s_branch L_rok_46
L_rspin_49:
    s_mov_b32 s52, 3
    s_call_b64 s[100:101], L_c_spin
    s_branch L_rok_48
L_rspin_57:
    s_mov_b32 s52, 4
    s_call_b64 s[100:101], L_c_spin
    s_branch L_rok_56
L_rspin_59:
    s_mov_b32 s52, 5
    s_call_b64 s[100:101], L_c_spin
    s_branch L_rok_58
L_rspin_63:
    s_mov_b32 s52, 6
    s_call_b64 s[100:101], L_c_spin
    s_branch L_rok_62
L_rspin_65:
    s_mov_b32 s52, 7
    s_call_b64 s[100:101], L_c_spin
    s_branch L_rok_64
L_rspin_67:
    s_mov_b32 s52, 8
    s_call_b64 s[100:101], L_c_spin
    s_branch L_rok_66
L_rspin_69:
    s_mov_b32 s52, 9
    s_call_b64 s[100:101], L_c_spin
    s_branch L_rok_68
L_rspin_71:
    s_mov_b32 s52, 10
    s_call_b64 s[100:101], L_c_spin
    s_branch L_rok_70
L_rspin_73:
    s_mov_b32 s52, 11
    s_call_b64 s[100:101], L_c_spin
    s_branch L_rok_72
L_rspin_80:
    s_mov_b32 s52, 12
    s_call_b64 s[100:101], L_c_spin
    s_branch L_rok_79
L_rspin_82:
    s_mov_b32 s52, 16
    s_call_b64 s[100:101], L_c_spin
    s_branch L_rok_81
L_rspin_84:
    s_mov_b32 s52, 13
    s_call_b64 s[100:101], L_c_spin
    s_branch L_rok_83
L_rspin_86:
    s_mov_b32 s52, 14
    s_call_b64 s[100:101], L_c_spin
    s_branch L_rok_85
L_rspin_88:
    s_mov_b32 s52, 15
    s_call_b64 s[100:101], L_c_spin
    s_branch L_rok_87
L_rspin_90:
    s_mov_b32 s52, 17
    s_call_b64 s[100:101], L_c_spin
    s_branch L_rok_89
L_rspin_92:
    s_mov_b32 s52, 18
    s_call_b64 s[100:101], L_c_spin
    s_branch L_rok_91
L_rspin_94:
    s_mov_b32 s52, 19
    s_call_b64 s[100:101], L_c_spin
    s_branch L_rok_93
L_rspin_96:
    s_mov_b32 s52, 20
    s_call_b64 s[100:101], L_c_spin
    s_branch L_rok_95
L_rspin_100:
    s_mov_b32 s52, 21
    s_call_b64 s[100:101], L_c_spin
    s_branch L_rok_99
L_c_spin:
    s_mov_b32 s54, 0
L_c_spin_loop:
    ds_read_b32 v13, v14
    s_add_u32 s54, s54, 1
    s_cmp_gt_u32 s54, 0x100000
    s_waitcnt lgkmcnt(0)
    v_readfirstlane_b32 s48, v13
    s_cbranch_scc1 L_c_spin_ret
    s_cmp_ge_u32 s48, s52
    s_cbranch_scc1 L_c_spin_ret
    s_branch L_c_spin_loop
L_c_spin_ret:
    s_setpc_b64 s[100:101]
L_end:
    s_endpgm
.section .rodata,"a"
.p2align 6
.amdhsa_kernel recurrent_scan__ssm_conv_s4__dense_activation_mish__prompt_kernel
  .amdhsa_next_free_vgpr 256
  .amdhsa_next_free_sgpr 102
  .amdhsa_accum_offset 256
  .amdhsa_group_segment_fixed_size 0
  .amdhsa_kernarg_size 128
  .amdhsa_user_sgpr_count 2
  .amdhsa_user_sgpr_kernarg_segment_ptr 1
  .amdhsa_system_sgpr_workgroup_id_x 1
.end_amdhsa_kernel
```
